```python
import torch

def _softmax(x, axis=-1):
    return torch.softmax(x, dim=axis)
def _gelu(x):
    return torch.nn.functional.gelu(x, approximate="tanh")
def _silu(x):
    return torch.nn.functional.silu(x)
def _sigmoid(x):
    return torch.sigmoid(x)
def _layernorm(x, axis=-1, eps=1e-5):
    m = x.mean(dim=axis, keepdim=True)
    v = x.var(dim=axis, keepdim=True, unbiased=False)
    return (x - m) / torch.sqrt(v + eps)
def _scatter_add(tgt, idx, src, axis=0):
    return tgt.clone().index_add_(axis, idx, src)
def _segment_sum(src, seg, n):
    out = torch.zeros((n,) + src.shape[1:], dtype=src.dtype)
    return out.index_add_(0, seg, src)
def _pad(x, pw):
    flat = tuple(v for pair in reversed(pw) for v in pair)
    return torch.nn.functional.pad(x, flat)

kernel_name = 'standalone__cheap_equivariant_egnn__graph'

def setup_inputs():

    _w = (lambda a: (lambda t: t.to(torch.bfloat16) if t.is_floating_point() else t)(torch.as_tensor(a)))
    N, deg, D, De = 10000, 16, 128, max(4, 1)
    E = N * deg
    return {
        "h": _w((lambda *s: torch.randn(*s, dtype=torch.bfloat16) * 0.2)(N, D)),
        "pos": _w((lambda *s: torch.randn(*s, dtype=torch.bfloat16) * 0.8)(N, 3)),
        "e_attr": _w((lambda *s: torch.randn(*s, dtype=torch.bfloat16) * 0.8)(E, De)),
        "src": _w((lambda lo, hi, *s: torch.randint(lo, hi, s))(0, N, E).to(torch.int64)),
        "dst": _w((lambda lo, hi, *s: torch.randint(lo, hi, s))(0, N, E).to(torch.int64)),
        "w_e": _w(0.1 * (lambda *s: torch.randn(*s, dtype=torch.bfloat16) * 0.8)(2 * D + 1 + De, D)),
        "w_x": _w(0.1 * (lambda *s: torch.randn(*s, dtype=torch.bfloat16) * 0.2)(D, 1)),
        "w_h": _w(0.1 * (lambda *s: torch.randn(*s, dtype=torch.bfloat16) * 0.2)(2 * D, D)),
    }

def reference(h, pos, e_attr, src, dst, w_e, w_x, w_h):
    N, D = h.shape[0], h.shape[1]
    diff = pos[dst] - pos[src]
    dist2 = torch.sum(diff * diff, axis=-1, keepdims=True)
    e_in = torch.concatenate([h[dst], h[src], dist2, e_attr], axis=-1)
    m_ij = _silu(e_in @ w_e)
    coord_scale = m_ij @ w_x
    pos_new = pos + _segment_sum(diff * coord_scale, dst, N)
    m_i = _segment_sum(m_ij, dst, N)
    h_new = h + _silu(torch.concatenate([h, m_i], axis=-1) @ w_h)
    return h_new, pos_new
```

```asm
; @launch kernel=egnn_k1_kernel grid=(235,1,1) block=(1024,1,1) lds=77824
; @launch kernel=egnn_k2_kernel grid=(250,1,1) block=(1024,1,1) lds=159360
.amdgcn_target "amdgcn-amd-amdhsa--gfx950"
.text
.globl egnn_k1_kernel
.p2align 8
.type egnn_k1_kernel,@function
egnn_k1_kernel:
    s_cmp_ge_u32 s2, 235
    s_cbranch_scc1 K1_END
    s_load_dwordx16 s[4:19], s[0:1], 0
    s_load_dwordx2 s[24:25], s[0:1], 80
    v_lshrrev_b32 v2, 6, v0
    v_and_b32 v1, 63, v0
    v_readfirstlane_b32 s40, v2
    s_cmp_ge_u32 s2, 64
    s_cbranch_scc1 K1_MAT
    v_lshlrev_b32 v3, 4, v0
    v_lshlrev_b32 v4, 4, v1
    v_mov_b32 v40, -1
    v_mov_b32 v41, -1
    v_mov_b32 v42, -1
    v_mov_b32 v43, -1
    v_mov_b32 v6, 0
    v_lshlrev_b32 v7, 2, v0
    v_add_u32 v7, 53248, v7
    ds_write_b128 v3, v[40:43] offset:0
    ds_write_b128 v3, v[40:43] offset:16384
    ds_write_b32 v7, v6
    s_cmp_ge_u32 s40, 10
    s_cbranch_scc1 K1_DMA
    s_mul_i32 s41, s2, 10000
    s_lshl_b32 s42, s40, 11
    s_add_u32 s43, s42, 32768
    s_mov_b32 m0, s43
    s_lshl_b32 s43, s41, 1
    s_add_u32 s43, s43, s42
    s_waitcnt lgkmcnt(0)
    s_mov_b32 s28, s12
    s_mov_b32 s29, s13
    s_mov_b32 s30, 640000
    s_mov_b32 s31, 0x20000
    buffer_load_dwordx4 v[12:15], v3, s[28:31], s41 offen
    s_mov_b32 s32, s10
    s_mov_b32 s33, s11
    s_mov_b32 s34, 640000
    s_mov_b32 s35, 0x20000
    buffer_load_dwordx4 v[16:19], v3, s[32:35], s41 offen
    s_barrier
    s_mov_b32 s52, s8
    s_mov_b32 s53, s9
    s_mov_b32 s54, 1280000
    s_mov_b32 s55, 0x20000
    buffer_load_dwordx4 v4, s[52:55], s43 offen offset:0 lds
    buffer_load_dwordx4 v4, s[52:55], s43 offen offset:1024 lds
    v_mov_b32 v5, 1
    v_lshrrev_b32 v28, 8, v0
    v_lshl_or_b32 v28, v0, 24, v28
    v_add_u32 v28, 0x100, v28
    v_add_u32 v29, 0x400000, v28
    v_add_u32 v30, 0x800000, v28
    v_add_u32 v31, 0xc00000, v28
    v_cmp_gt_u32 vcc, 625, v0
    s_mov_b64 s[46:47], vcc
    s_mov_b32 s49, 53248
    s_mov_b32 s50, -40
    s_mov_b32 s51, -124
    s_mov_b32 s44, -156
    s_mov_b64 exec, s[46:47]
    s_waitcnt vmcnt(3)
    v_mul_u32_u24 v20, 52429, v12
    v_lshrrev_b32 v20, 21, v20
    v_lshl_add_u32 v6, v20, 2, s49
    ds_add_rtn_u32 v24, v6, v5
    v_mul_u32_u24 v21, 52429, v13
    v_lshrrev_b32 v21, 21, v21
    v_lshl_add_u32 v6, v21, 2, s49
    ds_add_rtn_u32 v25, v6, v5
    v_mul_u32_u24 v22, 52429, v14
    v_lshrrev_b32 v22, 21, v22
    v_lshl_add_u32 v6, v22, 2, s49
    ds_add_rtn_u32 v26, v6, v5
    v_mul_u32_u24 v23, 52429, v15
    v_lshrrev_b32 v23, 21, v23
    v_lshl_add_u32 v6, v23, 2, s49
    ds_add_rtn_u32 v27, v6, v5
    v_mad_i32_i24 v12, v20, s50, v12
    v_mul_u32_u24 v7, 205, v12
    v_lshrrev_b32 v7, 10, v7
    v_lshl_add_u32 v12, v12, 5, v28
    v_mad_i32_i24 v12, v7, s44, v12
    v_mad_i32_i24 v13, v21, s50, v13
    v_mul_u32_u24 v7, 205, v13
    v_lshrrev_b32 v7, 10, v7
    v_lshl_add_u32 v13, v13, 5, v29
    v_mad_i32_i24 v13, v7, s44, v13
    v_mad_i32_i24 v14, v22, s50, v14
    v_mul_u32_u24 v7, 205, v14
    v_lshrrev_b32 v7, 10, v7
    v_lshl_add_u32 v14, v14, 5, v30
    v_mad_i32_i24 v14, v7, s44, v14
    v_mad_i32_i24 v15, v23, s50, v15
    v_mul_u32_u24 v7, 205, v15
    v_lshrrev_b32 v7, 10, v7
    v_lshl_add_u32 v15, v15, 5, v31
    v_mad_i32_i24 v15, v7, s44, v15
    s_waitcnt vmcnt(2)
    v_lshl_add_u32 v12, v16, 8, v12
    v_lshlrev_b32 v16, 7, v20
    v_lshl_add_u32 v13, v17, 8, v13
    v_lshlrev_b32 v17, 7, v21
    v_lshl_add_u32 v14, v18, 8, v14
    v_lshlrev_b32 v18, 7, v22
    v_lshl_add_u32 v15, v19, 8, v15
    v_lshlrev_b32 v19, 7, v23
    s_waitcnt lgkmcnt(0)
    v_max3_u32 v7, v24, v25, v26
    v_max_u32 v7, v7, v27
    v_cmp_le_u32 vcc, 32, v7
    v_lshl_add_u32 v16, v24, 3, v16
    v_lshrrev_b32 v6, 4, v24
    v_mad_i32_i24 v16, v6, s51, v16
    v_lshl_add_u32 v17, v25, 3, v17
    v_lshrrev_b32 v6, 4, v25
    v_mad_i32_i24 v17, v6, s51, v17
    v_lshl_add_u32 v18, v26, 3, v18
    v_lshrrev_b32 v6, 4, v26
    v_mad_i32_i24 v18, v6, s51, v18
    v_lshl_add_u32 v19, v27, 3, v19
    v_lshrrev_b32 v6, 4, v27
    v_mad_i32_i24 v19, v6, s51, v19
    s_cbranch_vccnz K1_SLOW
    ds_write_b32 v16, v12 offset:0
    ds_write_b32 v17, v13 offset:0
    ds_write_b32 v18, v14 offset:0
    ds_write_b32 v19, v15 offset:0
K1_JOIN:
    s_mov_b64 exec, -1
    s_branch K1_C
K1_DMA:
    s_waitcnt lgkmcnt(0)
    s_barrier
K1_C:
    v_lshlrev_b32 v3, 3, v0
    v_lshrrev_b32 v6, 4, v0
    v_and_b32 v7, 15, v0
    s_mov_b32 s42, 24576
    v_mul_u32_u24 v8, s42, v6
    v_lshl_add_u32 v5, v7, 3, v8
    s_lshl_b32 s28, s2, 8
    s_add_u32 s28, s28, 8192
    s_add_u32 s29, s28, 1572864
    s_add_u32 s30, s28, 3145728
    s_add_u32 s31, s28, 4718592
    s_lshl_b32 s52, s2, 7
    s_add_u32 s53, s52, 1572864
    s_add_u32 s54, s52, 3145728
    s_add_u32 s55, s52, 4718592
    s_mov_b32 s56, s24
    s_mov_b32 s57, s25
    s_mov_b32 s58, 6144000
    s_mov_b32 s59, 0x20000
    v_mov_b32 v8, 54248
    s_waitcnt vmcnt(0) lgkmcnt(0)
    s_barrier
    ds_read_b64 v[12:13], v3 offset:0
    ds_read_b64 v[14:15], v3 offset:8192
    ds_read_b64 v[16:17], v3 offset:16384
    ds_read_b64 v[18:19], v3 offset:24576
    ds_read_b32 v8, v8
    s_waitcnt lgkmcnt(4)
    v_alignbit_b32 v6, v12, v12, 19
    v_and_b32 v6, 0x7ff8, v6
    ds_read_b64 v[20:21], v6 offset:32768
    buffer_store_dwordx2 v[12:13], v5, s[56:59], s52 offen sc1
    s_waitcnt lgkmcnt(4)
    v_alignbit_b32 v6, v14, v14, 19
    v_and_b32 v6, 0x7ff8, v6
    ds_read_b64 v[22:23], v6 offset:32768
    buffer_store_dwordx2 v[14:15], v5, s[56:59], s53 offen sc1
    s_waitcnt lgkmcnt(4)
    v_alignbit_b32 v6, v16, v16, 19
    v_and_b32 v6, 0x7ff8, v6
    ds_read_b64 v[24:25], v6 offset:32768
    buffer_store_dwordx2 v[16:17], v5, s[56:59], s54 offen sc1
    s_waitcnt lgkmcnt(4)
    v_alignbit_b32 v6, v18, v18, 19
    v_and_b32 v6, 0x7ff8, v6
    ds_read_b64 v[26:27], v6 offset:32768
    buffer_store_dwordx2 v[18:19], v5, s[56:59], s55 offen sc1
    s_waitcnt lgkmcnt(3)
    buffer_store_dwordx2 v[20:21], v5, s[56:59], s28 offen offset:0
    s_waitcnt lgkmcnt(2)
    buffer_store_dwordx2 v[22:23], v5, s[56:59], s29 offen offset:0
    s_waitcnt lgkmcnt(1)
    buffer_store_dwordx2 v[24:25], v5, s[56:59], s30 offen offset:0
    s_waitcnt lgkmcnt(0)
    buffer_store_dwordx2 v[26:27], v5, s[56:59], s31 offen offset:0
    v_and_b32 v6, v13, v15
    v_and_b32 v7, v17, v19
    v_and_b32 v6, v6, v7
    v_cmp_ne_u32 vcc, -1, v6
    v_readfirstlane_b32 s44, v8
    s_cbranch_vccz K1_O1
    v_alignbit_b32 v6, v13, v13, 19
    v_and_b32 v6, 0x7ff8, v6
    ds_read_b64 v[28:29], v6 offset:32768
    v_alignbit_b32 v6, v15, v15, 19
    v_and_b32 v6, 0x7ff8, v6
    ds_read_b64 v[30:31], v6 offset:32768
    v_alignbit_b32 v6, v17, v17, 19
    v_and_b32 v6, 0x7ff8, v6
    ds_read_b64 v[32:33], v6 offset:32768
    v_alignbit_b32 v6, v19, v19, 19
    v_and_b32 v6, 0x7ff8, v6
    ds_read_b64 v[34:35], v6 offset:32768
    s_waitcnt lgkmcnt(3)
    buffer_store_dwordx2 v[28:29], v5, s[56:59], s28 offen offset:128
    s_waitcnt lgkmcnt(2)
    buffer_store_dwordx2 v[30:31], v5, s[56:59], s29 offen offset:128
    s_waitcnt lgkmcnt(1)
    buffer_store_dwordx2 v[32:33], v5, s[56:59], s30 offen offset:128
    s_waitcnt lgkmcnt(0)
    buffer_store_dwordx2 v[34:35], v5, s[56:59], s31 offen offset:128
K1_O1:
    s_mov_b32 s58, 24117248
    s_cmp_lg_u32 s40, 0
    s_cbranch_scc1 K1_O2
    s_mov_b64 exec, 1
    s_lshl_b32 s41, s2, 2
    s_add_u32 s41, s41, 17039360
    buffer_store_dword v8, v0, s[56:59], s41 offen
    s_mov_b64 exec, -1
K1_O2:
    s_cmp_eq_u32 s44, 0
    s_cbranch_scc1 K1_ENDP
    s_lshl_b32 s41, s2, 14
    s_add_u32 s42, s41, 23068672
    s_add_u32 s41, s41, 22020096
    s_lshl_b32 s43, s2, 15
    s_add_u32 s43, s43, 17825792
    v_add_u32 v8, 0, v0
    v_cmp_gt_u32 vcc, s44, v8
    s_and_b64 exec, exec, vcc
    s_cbranch_execz K1_ENDP
    v_lshlrev_b32 v5, 3, v8
    v_add_u32 v6, 57344, v5
    ds_read_b64 v[36:37], v6
    v_lshrrev_b32 v6, 5, v8
    v_lshlrev_b32 v4, 7, v6
    v_and_b32 v7, 15, v8
    v_lshl_add_u32 v4, v7, 3, v4
    v_bfe_u32 v7, v8, 4, 1
    v_lshl_add_u32 v4, v7, 2, v4
    s_waitcnt lgkmcnt(0)
    v_alignbit_b32 v6, v36, v36, 19
    v_and_b32 v6, 0x7ff8, v6
    ds_read_b64 v[38:39], v6 offset:32768
    buffer_store_dword v36, v4, s[56:59], s41 offen
    buffer_store_dword v37, v4, s[56:59], s42 offen
    s_waitcnt lgkmcnt(0)
    buffer_store_dwordx2 v[38:39], v5, s[56:59], s43 offen
    s_waitcnt vmcnt(0)
    v_add_u32 v8, 1024, v0
    v_cmp_gt_u32 vcc, s44, v8
    s_and_b64 exec, exec, vcc
    s_cbranch_execz K1_ENDP
    v_lshlrev_b32 v5, 3, v8
    v_add_u32 v6, 57344, v5
    ds_read_b64 v[36:37], v6
    v_lshrrev_b32 v6, 5, v8
    v_lshlrev_b32 v4, 7, v6
    v_and_b32 v7, 15, v8
    v_lshl_add_u32 v4, v7, 3, v4
    v_bfe_u32 v7, v8, 4, 1
    v_lshl_add_u32 v4, v7, 2, v4
    s_waitcnt lgkmcnt(0)
    v_alignbit_b32 v6, v36, v36, 19
    v_and_b32 v6, 0x7ff8, v6
    ds_read_b64 v[38:39], v6 offset:32768
    buffer_store_dword v36, v4, s[56:59], s41 offen
    buffer_store_dword v37, v4, s[56:59], s42 offen
    s_waitcnt lgkmcnt(0)
    buffer_store_dwordx2 v[38:39], v5, s[56:59], s43 offen
    s_waitcnt vmcnt(0)
    v_add_u32 v8, 2048, v0
    v_cmp_gt_u32 vcc, s44, v8
    s_and_b64 exec, exec, vcc
    s_cbranch_execz K1_ENDP
    v_lshlrev_b32 v5, 3, v8
    v_add_u32 v6, 57344, v5
    ds_read_b64 v[36:37], v6
    v_lshrrev_b32 v6, 5, v8
    v_lshlrev_b32 v4, 7, v6
    v_and_b32 v7, 15, v8
    v_lshl_add_u32 v4, v7, 3, v4
    v_bfe_u32 v7, v8, 4, 1
    v_lshl_add_u32 v4, v7, 2, v4
    s_waitcnt lgkmcnt(0)
    v_alignbit_b32 v6, v36, v36, 19
    v_and_b32 v6, 0x7ff8, v6
    ds_read_b64 v[38:39], v6 offset:32768
    buffer_store_dword v36, v4, s[56:59], s41 offen
    buffer_store_dword v37, v4, s[56:59], s42 offen
    s_waitcnt lgkmcnt(0)
    buffer_store_dwordx2 v[38:39], v5, s[56:59], s43 offen
    s_waitcnt vmcnt(0)
    s_endpgm
K1_SLOW:
    v_mov_b32 v7, 54248
    v_cmp_gt_u32 vcc, 32, v24
    s_and_b64 exec, exec, vcc
    s_cbranch_execz K1_S_2
    ds_write_b32 v16, v12 offset:0
K1_S_2:
    s_mov_b64 exec, s[46:47]
    v_cmp_le_u32 vcc, 32, v24
    s_and_b64 exec, exec, vcc
    s_cbranch_execz K1_S_1
    ds_add_rtn_u32 v6, v7, v5
    s_waitcnt lgkmcnt(0)
    v_lshlrev_b32 v6, 3, v6
    v_add_u32 v6, 57344, v6
    ds_write_b32 v6, v12
    ds_write_b32 v6, v20 offset:4
K1_S_1:
    s_mov_b64 exec, s[46:47]
    v_cmp_gt_u32 vcc, 32, v25
    s_and_b64 exec, exec, vcc
    s_cbranch_execz K1_S_4
    ds_write_b32 v17, v13 offset:0
K1_S_4:
    s_mov_b64 exec, s[46:47]
    v_cmp_le_u32 vcc, 32, v25
    s_and_b64 exec, exec, vcc
    s_cbranch_execz K1_S_3
    ds_add_rtn_u32 v6, v7, v5
    s_waitcnt lgkmcnt(0)
    v_lshlrev_b32 v6, 3, v6
    v_add_u32 v6, 57344, v6
    ds_write_b32 v6, v13
    ds_write_b32 v6, v21 offset:4
K1_S_3:
    s_mov_b64 exec, s[46:47]
    v_cmp_gt_u32 vcc, 32, v26
    s_and_b64 exec, exec, vcc
    s_cbranch_execz K1_S_6
    ds_write_b32 v18, v14 offset:0
K1_S_6:
    s_mov_b64 exec, s[46:47]
    v_cmp_le_u32 vcc, 32, v26
    s_and_b64 exec, exec, vcc
    s_cbranch_execz K1_S_5
    ds_add_rtn_u32 v6, v7, v5
    s_waitcnt lgkmcnt(0)
    v_lshlrev_b32 v6, 3, v6
    v_add_u32 v6, 57344, v6
    ds_write_b32 v6, v14
    ds_write_b32 v6, v22 offset:4
K1_S_5:
    s_mov_b64 exec, s[46:47]
    v_cmp_gt_u32 vcc, 32, v27
    s_and_b64 exec, exec, vcc
    s_cbranch_execz K1_S_8
    ds_write_b32 v19, v15 offset:0
K1_S_8:
    s_mov_b64 exec, s[46:47]
    v_cmp_le_u32 vcc, 32, v27
    s_and_b64 exec, exec, vcc
    s_cbranch_execz K1_S_7
    ds_add_rtn_u32 v6, v7, v5
    s_waitcnt lgkmcnt(0)
    v_lshlrev_b32 v6, 3, v6
    v_add_u32 v6, 57344, v6
    ds_write_b32 v6, v15
    ds_write_b32 v6, v23 offset:4
K1_S_7:
    s_mov_b64 exec, s[46:47]
    s_nop 0
    s_branch K1_JOIN
K1_MAT:
    v_and_b32 v2, 15, v0
    v_lshrrev_b32 v3, 4, v1
    s_sub_u32 s48, s2, 64
    s_cmp_ge_u32 s48, 158
    s_cbranch_scc1 K1_PREP0
    s_and_b32 s42, s48, 1
    s_lshr_b32 s43, s48, 1
    s_lshl_b32 s43, s43, 15
    s_lshl_b32 s44, s40, 12
    s_mov_b32 m0, s44
    s_cmp_ge_u32 s44, 0x8000
    s_cbranch_scc1 K1_G0
    v_lshlrev_b32 v5, 2, v3
    v_xor_b32 v5, v5, v2
    v_lshlrev_b32 v5, 4, v5
    v_lshl_add_u32 v5, v3, 8, v5
    s_xor_b32 s45, s42, 1
    s_lshl_b32 s45, s45, 15
    s_add_u32 s45, s45, s44
    s_waitcnt lgkmcnt(0)
    s_mov_b32 s28, s14
    s_mov_b32 s29, s15
    s_mov_b32 s30, 66816
    s_mov_b32 s31, 0x20000
    buffer_load_dwordx4 v5, s[28:31], s45 offen offset:0 lds
    buffer_load_dwordx4 v5, s[28:31], s45 offen offset:1024 lds
    buffer_load_dwordx4 v5, s[28:31], s45 offen offset:2048 lds
    buffer_load_dwordx4 v5, s[28:31], s45 offen offset:3072 lds
    s_branch K1_G1
K1_G0:
    v_xor_b32 v5, v3, v2
    v_lshlrev_b32 v5, 4, v5
    v_lshl_add_u32 v5, v3, 8, v5
    v_xor_b32 v6, 64, v5
    v_xor_b32 v7, 128, v5
    v_xor_b32 v8, 192, v5
    s_add_u32 s45, s43, s44
    s_sub_u32 s45, s45, 32768
    s_waitcnt lgkmcnt(0)
    s_mov_b32 s28, s4
    s_mov_b32 s29, s5
    s_mov_b32 s30, 2560000
    s_mov_b32 s31, 0x20000
    buffer_load_dwordx4 v5, s[28:31], s45 offen offset:0 lds
    buffer_load_dwordx4 v6, s[28:31], s45 offen offset:1024 lds
    buffer_load_dwordx4 v7, s[28:31], s45 offen offset:2048 lds
    buffer_load_dwordx4 v8, s[28:31], s45 offen offset:3072 lds
K1_G1:
    s_and_b32 s41, s40, 3
    s_lshr_b32 s46, s40, 2
    v_lshrrev_b32 v9, 2, v2
    v_xor_b32 v10, s41, v9
    v_and_b32 v11, 3, v2
    v_lshl_add_u32 v10, v10, 2, v11
    v_lshlrev_b32 v10, 4, v10
    v_lshl_add_u32 v10, v9, 8, v10
    v_lshl_add_u32 v100, v3, 11, v10
    v_xor_b32 v10, v3, v2
    v_lshlrev_b32 v10, 4, v10
    v_lshl_add_u32 v10, v2, 8, v10
    s_lshl_b32 s47, s46, 13
    s_add_u32 s49, s47, 32768
    v_add_u32 v101, s49, v10
    v_xor_b32 v102, 64, v101
    v_xor_b32 v103, 128, v101
    v_xor_b32 v104, 192, v101
    v_lshlrev_b32 v105, 8, v2
    v_lshl_add_u32 v105, v3, 4, v105
    s_lshl_b32 s52, s41, 6
    s_add_u32 s52, s52, s47
    s_add_u32 s52, s52, s43
    s_mov_b32 s62, 0xbfb8aa3b
    s_mov_b32 s63, 0xbfb8aa3b
    s_mov_b32 s61, 0x7fff0000
    s_mov_b32 s60, 0x8000
    s_waitcnt vmcnt(0)
    s_barrier
    ds_read_b64_tr_b16 v[8:9], v100 offset:0
    ds_read_b64_tr_b16 v[10:11], v100 offset:1024
    ds_read_b64_tr_b16 v[12:13], v100 offset:8
    ds_read_b64_tr_b16 v[14:15], v100 offset:1032
    ds_read_b128 v[40:43], v101 offset:0
    ds_read_b128 v[44:47], v101 offset:4096
    ds_read_b64_tr_b16 v[16:17], v100 offset:8192
    ds_read_b64_tr_b16 v[18:19], v100 offset:9216
    ds_read_b64_tr_b16 v[20:21], v100 offset:8200
    ds_read_b64_tr_b16 v[22:23], v100 offset:9224
    ds_read_b128 v[48:51], v102 offset:0
    ds_read_b128 v[52:55], v102 offset:4096
    ds_read_b64_tr_b16 v[24:25], v100 offset:16384
    ds_read_b64_tr_b16 v[26:27], v100 offset:17408
    ds_read_b64_tr_b16 v[28:29], v100 offset:16392
    ds_read_b64_tr_b16 v[30:31], v100 offset:17416
    ds_read_b128 v[56:59], v103 offset:0
    ds_read_b128 v[60:63], v103 offset:4096
    ds_read_b64_tr_b16 v[32:33], v100 offset:24576
    ds_read_b64_tr_b16 v[34:35], v100 offset:25600
    ds_read_b64_tr_b16 v[36:37], v100 offset:24584
    ds_read_b64_tr_b16 v[38:39], v100 offset:25608
    ds_read_b128 v[64:67], v104 offset:0
    ds_read_b128 v[68:71], v104 offset:4096
    s_waitcnt lgkmcnt(15)
    v_mfma_f32_16x16x32_bf16 v[72:75], v[8:11], v[40:43], 0
    v_mfma_f32_16x16x32_bf16 v[76:79], v[12:15], v[40:43], 0
    v_mfma_f32_16x16x32_bf16 v[80:83], v[8:11], v[44:47], 0
    v_mfma_f32_16x16x32_bf16 v[84:87], v[12:15], v[44:47], 0
    s_waitcnt lgkmcnt(12)
    v_mfma_f32_16x16x32_bf16 v[72:75], v[16:19], v[48:51], v[72:75]
    v_mfma_f32_16x16x32_bf16 v[76:79], v[20:23], v[48:51], v[76:79]
    v_mfma_f32_16x16x32_bf16 v[80:83], v[16:19], v[52:55], v[80:83]
    v_mfma_f32_16x16x32_bf16 v[84:87], v[20:23], v[52:55], v[84:87]
    s_waitcnt lgkmcnt(6)
    v_mfma_f32_16x16x32_bf16 v[72:75], v[24:27], v[56:59], v[72:75]
    v_mfma_f32_16x16x32_bf16 v[76:79], v[28:31], v[56:59], v[76:79]
    v_mfma_f32_16x16x32_bf16 v[80:83], v[24:27], v[60:63], v[80:83]
    v_mfma_f32_16x16x32_bf16 v[84:87], v[28:31], v[60:63], v[84:87]
    s_waitcnt lgkmcnt(0)
    v_mfma_f32_16x16x32_bf16 v[72:75], v[32:35], v[64:67], v[72:75]
    v_mfma_f32_16x16x32_bf16 v[76:79], v[36:39], v[64:67], v[76:79]
    v_mfma_f32_16x16x32_bf16 v[80:83], v[32:35], v[68:71], v[80:83]
    v_mfma_f32_16x16x32_bf16 v[84:87], v[36:39], v[68:71], v[84:87]
    s_cmp_lg_u32 s42, 0
    s_cbranch_scc1 K1_GA
    s_mov_b32 s36, s24
    s_mov_b32 s37, s25
    s_mov_b32 s38, 13046016
    s_mov_b32 s39, 0x20000
    s_add_u32 s52, s52, 10486016
    v_pk_mul_f32 v[72:73], v[72:73], s[62:63]
    v_pk_mul_f32 v[74:75], v[74:75], s[62:63]
    v_pk_mul_f32 v[76:77], v[76:77], s[62:63]
    v_pk_mul_f32 v[78:79], v[78:79], s[62:63]
    v_cvt_pk_bf16_f32 v72, v72, v73
    v_and_b32 v73, 0x7fffffff, v73
    v_sub_u32_sdwa v8, s60, v72 dst_sel:DWORD dst_unused:UNUSED_PAD src0_sel:DWORD src1_sel:WORD_0
    s_nop 0
    v_add_u32 v73, v73, v8
    v_max_i32 v73, 0, v73
    v_bfi_b32 v8, s61, v73, v72
    v_cvt_pk_bf16_f32 v74, v74, v75
    v_and_b32 v75, 0x7fffffff, v75
    v_sub_u32_sdwa v9, s60, v74 dst_sel:DWORD dst_unused:UNUSED_PAD src0_sel:DWORD src1_sel:WORD_0
    s_nop 0
    v_add_u32 v75, v75, v9
    v_max_i32 v75, 0, v75
    v_bfi_b32 v9, s61, v75, v74
    v_cvt_pk_bf16_f32 v76, v76, v77
    v_and_b32 v77, 0x7fffffff, v77
    v_sub_u32_sdwa v10, s60, v76 dst_sel:DWORD dst_unused:UNUSED_PAD src0_sel:DWORD src1_sel:WORD_0
    s_nop 0
    v_add_u32 v77, v77, v10
    v_max_i32 v77, 0, v77
    v_bfi_b32 v10, s61, v77, v76
    v_cvt_pk_bf16_f32 v78, v78, v79
    v_and_b32 v79, 0x7fffffff, v79
    v_sub_u32_sdwa v11, s60, v78 dst_sel:DWORD dst_unused:UNUSED_PAD src0_sel:DWORD src1_sel:WORD_0
    s_nop 0
    v_add_u32 v79, v79, v11
    v_max_i32 v79, 0, v79
    v_bfi_b32 v11, s61, v79, v78
    buffer_store_dwordx4 v[8:11], v105, s[36:39], s52 offen sc1
    s_add_u32 s52, s52, 4096
    v_pk_mul_f32 v[80:81], v[80:81], s[62:63]
    v_pk_mul_f32 v[82:83], v[82:83], s[62:63]
    v_pk_mul_f32 v[84:85], v[84:85], s[62:63]
    v_pk_mul_f32 v[86:87], v[86:87], s[62:63]
    v_cvt_pk_bf16_f32 v80, v80, v81
    v_and_b32 v81, 0x7fffffff, v81
    v_sub_u32_sdwa v12, s60, v80 dst_sel:DWORD dst_unused:UNUSED_PAD src0_sel:DWORD src1_sel:WORD_0
    s_nop 0
    v_add_u32 v81, v81, v12
    v_max_i32 v81, 0, v81
    v_bfi_b32 v12, s61, v81, v80
    v_cvt_pk_bf16_f32 v82, v82, v83
    v_and_b32 v83, 0x7fffffff, v83
    v_sub_u32_sdwa v13, s60, v82 dst_sel:DWORD dst_unused:UNUSED_PAD src0_sel:DWORD src1_sel:WORD_0
    s_nop 0
    v_add_u32 v83, v83, v13
    v_max_i32 v83, 0, v83
    v_bfi_b32 v13, s61, v83, v82
    v_cvt_pk_bf16_f32 v84, v84, v85
    v_and_b32 v85, 0x7fffffff, v85
    v_sub_u32_sdwa v14, s60, v84 dst_sel:DWORD dst_unused:UNUSED_PAD src0_sel:DWORD src1_sel:WORD_0
    s_nop 0
    v_add_u32 v85, v85, v14
    v_max_i32 v85, 0, v85
    v_bfi_b32 v14, s61, v85, v84
    v_cvt_pk_bf16_f32 v86, v86, v87
    v_and_b32 v87, 0x7fffffff, v87
    v_sub_u32_sdwa v15, s60, v86 dst_sel:DWORD dst_unused:UNUSED_PAD src0_sel:DWORD src1_sel:WORD_0
    s_nop 0
    v_add_u32 v87, v87, v15
    v_max_i32 v87, 0, v87
    v_bfi_b32 v15, s61, v87, v86
    buffer_store_dwordx4 v[12:15], v105, s[36:39], s52 offen sc1
    s_endpgm
K1_GA:
    s_mov_b32 s36, s24
    s_mov_b32 s37, s25
    s_mov_b32 s38, 16191488
    s_mov_b32 s39, 0x20000
    s_add_u32 s52, s52, 13631488
    v_pk_mul_f32 v[72:73], v[72:73], s[62:63]
    v_pk_mul_f32 v[74:75], v[74:75], s[62:63]
    v_pk_mul_f32 v[76:77], v[76:77], s[62:63]
    v_pk_mul_f32 v[78:79], v[78:79], s[62:63]
    v_cvt_pk_bf16_f32 v8, v72, v73
    v_cvt_pk_bf16_f32 v9, v74, v75
    v_cvt_pk_bf16_f32 v10, v76, v77
    v_cvt_pk_bf16_f32 v11, v78, v79
    buffer_store_dwordx4 v[8:11], v105, s[36:39], s52 offen
    s_add_u32 s52, s52, 4096
    v_pk_mul_f32 v[80:81], v[80:81], s[62:63]
    v_pk_mul_f32 v[82:83], v[82:83], s[62:63]
    v_pk_mul_f32 v[84:85], v[84:85], s[62:63]
    v_pk_mul_f32 v[86:87], v[86:87], s[62:63]
    v_cvt_pk_bf16_f32 v12, v80, v81
    v_cvt_pk_bf16_f32 v13, v82, v83
    v_cvt_pk_bf16_f32 v14, v84, v85
    v_cvt_pk_bf16_f32 v15, v86, v87
    buffer_store_dwordx4 v[12:15], v105, s[36:39], s52 offen
    s_endpgm
K1_PREP0:
    s_cmp_lt_u32 s48, 161
    s_cbranch_scc1 K1_PREP1
    s_sub_u32 s51, s48, 161
    v_mov_b32 v8, 0
    v_mov_b32 v9, 0
    v_mov_b32 v10, 0
    v_mov_b32 v11, 0
    v_mul_u32_u24 v6, 6, v0
    v_lshlrev_b32 v7, 4, v0
    s_mul_i32 s52, s51, 6144
    s_lshl_b32 s53, s51, 14
    s_add_u32 s53, s53, 17301504
    s_waitcnt lgkmcnt(0)
    s_mov_b32 s28, s6
    s_mov_b32 s29, s7
    s_mov_b32 s30, 60000
    s_mov_b32 s31, 0x20000
    buffer_load_short_d16_hi v8, v6, s[28:31], s52 offen offset:0
    buffer_load_short_d16_hi v9, v6, s[28:31], s52 offen offset:2
    buffer_load_short_d16_hi v10, v6, s[28:31], s52 offen offset:4
    s_mov_b32 s36, s24
    s_mov_b32 s37, s25
    s_mov_b32 s38, 17461504
    s_mov_b32 s39, 0x20000
    s_waitcnt vmcnt(0)
    buffer_store_dwordx4 v[8:11], v7, s[36:39], s53 offen sc1
    s_endpgm
K1_PREP1:
    s_cmp_ge_u32 s40, 8
    s_cbranch_scc1 K1_ENDP
    v_lshlrev_b32 v4, 11, v3
    v_lshl_add_u32 v4, v2, 2, v4
    s_and_b32 s41, s40, 3
    s_lshr_b32 s42, s40, 2
    s_lshl_b32 s44, s41, 6
    s_mov_b32 s46, 0x05040100
    s_mov_b32 s47, 0x07060302
    s_sub_u32 s51, s48, 158
    s_waitcnt lgkmcnt(0)
    s_mov_b32 s36, s24
    s_mov_b32 s37, s25
    s_mov_b32 s38, 24117248
    s_mov_b32 s39, 0x20000
    s_cmp_lg_u32 s51, 0
    s_cbranch_scc1 K1_P1
    s_cmp_ge_u32 s40, 1
    s_cbranch_scc1 K1_ENDP
    s_mov_b32 s28, s14
    s_mov_b32 s29, s15
    s_mov_b32 s30, 66816
    s_mov_b32 s31, 0x20000
    v_lshlrev_b32 v6, 2, v1
    s_mov_b32 s52, 65536
    buffer_load_dword v8, v6, s[28:31], s52 offen offset:0
    buffer_load_dword v9, v6, s[28:31], s52 offen offset:256
    buffer_load_dword v10, v6, s[28:31], s52 offen offset:512
    buffer_load_dword v11, v6, s[28:31], s52 offen offset:768
    buffer_load_dword v12, v6, s[28:31], s52 offen offset:1024
    s_mov_b32 s60, 0xbfb8aa3b
    s_mov_b32 s53, 16191488
    v_mov_b32 v30, 0
    s_mov_b32 s54, 10485760
    buffer_store_dword v30, v6, s[36:39], s54 offen
    s_waitcnt vmcnt(0)
    v_and_b32 v16, 0xffff0000, v8
    v_lshlrev_b32 v8, 16, v8
    v_mul_f32 v16, s60, v16
    v_mul_f32 v8, s60, v8
    v_cvt_pk_bf16_f32 v28, v8, v16
    v_and_b32 v17, 0xffff0000, v9
    v_lshlrev_b32 v9, 16, v9
    v_mul_f32 v17, s60, v17
    v_mul_f32 v9, s60, v9
    v_cvt_pk_bf16_f32 v24, v9, v17
    v_and_b32 v18, 0xffff0000, v10
    v_lshlrev_b32 v10, 16, v10
    v_mul_f32 v18, s60, v18
    v_mul_f32 v10, s60, v10
    v_cvt_pk_bf16_f32 v25, v10, v18
    v_and_b32 v19, 0xffff0000, v11
    v_lshlrev_b32 v11, 16, v11
    v_mul_f32 v19, s60, v19
    v_mul_f32 v11, s60, v11
    v_cvt_pk_bf16_f32 v26, v11, v19
    v_and_b32 v20, 0xffff0000, v12
    v_lshlrev_b32 v12, 16, v12
    v_mul_f32 v20, s60, v20
    v_mul_f32 v12, s60, v12
    v_cvt_pk_bf16_f32 v27, v12, v20
    v_lshlrev_b32 v22, 16, v28
    v_and_b32 v23, 0xffff0000, v28
    v_sub_f32 v22, v8, v22
    v_sub_f32 v23, v16, v23
    v_cvt_pk_bf16_f32 v29, v22, v23
    buffer_store_dword v24, v6, s[36:39], s53 offen offset:0
    buffer_store_dword v25, v6, s[36:39], s53 offen offset:256
    buffer_store_dword v26, v6, s[36:39], s53 offen offset:512
    buffer_store_dword v27, v6, s[36:39], s53 offen offset:768
    buffer_store_dword v28, v6, s[36:39], s53 offen offset:1024
    buffer_store_dword v29, v6, s[36:39], s53 offen offset:1280
    s_endpgm
K1_P1:
    s_mov_b32 s28, s18
    s_mov_b32 s29, s19
    s_mov_b32 s30, 65536
    s_mov_b32 s31, 0x20000
    s_lshl_b32 s43, s42, 14
    s_add_u32 s43, s43, s44
    s_sub_u32 s52, s51, 1
    s_lshl_b32 s52, s52, 15
    s_add_u32 s43, s43, s52
    s_add_u32 s45, s43, 8192
    buffer_load_dword v8, v4, s[28:31], s43 offen offset:0
    buffer_load_dword v9, v4, s[28:31], s43 offen offset:256
    buffer_load_dword v10, v4, s[28:31], s43 offen offset:512
    buffer_load_dword v11, v4, s[28:31], s43 offen offset:768
    buffer_load_dword v12, v4, s[28:31], s43 offen offset:1024
    buffer_load_dword v13, v4, s[28:31], s43 offen offset:1280
    buffer_load_dword v14, v4, s[28:31], s43 offen offset:1536
    buffer_load_dword v15, v4, s[28:31], s43 offen offset:1792
    buffer_load_dword v16, v4, s[28:31], s45 offen offset:0
    buffer_load_dword v17, v4, s[28:31], s45 offen offset:256
    buffer_load_dword v18, v4, s[28:31], s45 offen offset:512
    buffer_load_dword v19, v4, s[28:31], s45 offen offset:768
    buffer_load_dword v20, v4, s[28:31], s45 offen offset:1024
    buffer_load_dword v21, v4, s[28:31], s45 offen offset:1280
    buffer_load_dword v22, v4, s[28:31], s45 offen offset:1536
    buffer_load_dword v23, v4, s[28:31], s45 offen offset:1792
    s_lshl_b32 s52, s51, 15
    s_lshl_b32 s53, s41, 13
    s_add_u32 s52, s52, s53
    s_lshl_b32 s53, s42, 11
    s_add_u32 s52, s52, s53
    s_add_u32 s52, s52, 16777216
    v_lshrrev_b32 v6, 3, v2
    v_and_b32 v7, 7, v2
    v_lshlrev_b32 v6, 12, v6
    v_lshl_add_u32 v6, v7, 5, v6
    v_lshl_add_u32 v6, v3, 8, v6
    s_waitcnt vmcnt(8)
    v_perm_b32 v40, v9, v8, s46
    v_perm_b32 v44, v9, v8, s47
    v_perm_b32 v41, v11, v10, s46
    v_perm_b32 v45, v11, v10, s47
    v_perm_b32 v42, v13, v12, s46
    v_perm_b32 v46, v13, v12, s47
    v_perm_b32 v43, v15, v14, s46
    v_perm_b32 v47, v15, v14, s47
    s_waitcnt vmcnt(0)
    v_perm_b32 v48, v17, v16, s46
    v_perm_b32 v52, v17, v16, s47
    v_perm_b32 v49, v19, v18, s46
    v_perm_b32 v53, v19, v18, s47
    v_perm_b32 v50, v21, v20, s46
    v_perm_b32 v54, v21, v20, s47
    v_perm_b32 v51, v23, v22, s46
    v_perm_b32 v55, v23, v22, s47
    buffer_store_dwordx4 v[40:43], v6, s[36:39], s52 offen offset:0
    buffer_store_dwordx4 v[44:47], v6, s[36:39], s52 offen offset:16
    buffer_store_dwordx4 v[48:51], v6, s[36:39], s52 offen offset:1024
    buffer_store_dwordx4 v[52:55], v6, s[36:39], s52 offen offset:1040
K1_ENDP:
K1_END:
    s_endpgm
.globl egnn_k2_kernel
.p2align 8
.type egnn_k2_kernel,@function
egnn_k2_kernel:
    s_cmp_ge_u32 s2, 250
    s_cbranch_scc1 K2_END
    s_load_dwordx2 s[52:53], s[0:1], 80
    s_load_dwordx16 s[4:19], s[0:1], 0
    s_load_dwordx2 s[56:57], s[0:1], 80
    s_load_dwordx2 s[48:49], s[0:1], 64
    v_lshlrev_b32 v82, 3, v0
    v_lshlrev_b32 v4, 4, v0
    v_lshrrev_b32 v126, 4, v0
    v_lshl_add_u32 v7, v126, 7, v82
    v_add_u32 v7, 0x2000, v7
    s_mov_b32 s54, 24117248
    s_mov_b32 s55, 0x20000
    s_mul_i32 s94, s2, 24576
    v_lshrrev_b32 v127, 6, v0
    v_and_b32 v1, 63, v0
    v_readfirstlane_b32 s60, v127
    v_mov_b32 v98, 0
    v_mov_b32 v99, 0
    v_mov_b32 v100, 0
    v_mov_b32 v101, 0
    s_waitcnt lgkmcnt(0)
    buffer_load_dwordx2 v[2:3], v82, s[52:55], s94 offen
    buffer_load_dwordx2 v[12:13], v7, s[52:55], s94 offen
    v_lshlrev_b32 v84, 4, v1
    s_cmp_ge_u32 s60, 10
    s_cbranch_scc1 K2_P1
    s_mul_i32 s85, s2, 10240
    s_mov_b32 s28, s4
    s_mov_b32 s29, s5
    s_mov_b32 s30, 2560000
    s_mov_b32 s31, 0x20000
    buffer_load_dwordx4 v[34:37], v4, s[28:31], s85 offen
    v_lshl_add_u32 v38, v126, 4, v4
    v_add_u32 v38, 82944, v38
    s_mov_b64 s[90:91], -1
    s_branch K2_P2
K2_P1:
    s_cmp_lg_u32 s60, 11
    s_cbranch_scc1 K2_P3
    s_mov_b32 s28, s16
    s_mov_b32 s29, s17
    s_mov_b32 s30, 256
    s_mov_b32 s31, 0x20000
    buffer_load_dwordx4 v[34:37], v84, s[28:31], 0 offen
    v_add_u32 v38, 82688, v84
    s_mov_b64 s[90:91], 0xffff
    s_branch K2_P2
K2_P3:
    s_mul_i32 s85, s2, 640
    s_add_u32 s85, s85, 17301504
    v_min_u32 v38, 624, v84
    buffer_load_dwordx4 v[34:37], v38, s[52:55], s85 offen
    v_mul_u32_u24 v39, 205, v1
    v_lshrrev_b32 v39, 10, v39
    v_mul_u32_u24 v39, 624, v39
    v_lshlrev_b32 v38, 7, v1
    v_sub_u32 v38, v38, v39
    v_add_u32 v38, 82048, v38
    s_mov_b32 s90, -1
    s_mov_b32 s91, 0xff
K2_P2:
    s_lshr_b32 s61, s60, 1
    s_and_b32 s62, s60, 1
    s_lshl_b32 s64, s62, 7
    s_mul_i32 s71, s2, 10240
    s_mul_i32 s70, s61, 1280
    s_add_u32 s71, s71, s70
    s_sub_u32 s70, 2559872, s71
    s_add_u32 s43, s71, s64
    s_add_u32 s43, s43, 13631488
    v_lshlrev_b32 v83, 2, v1
    v_lshrrev_b32 v85, 5, v1
    v_mad_u32_u24 v39, v85, s70, v83
    v_mov_b32 v10, v83
    v_and_b32 v118, 7, v1
    v_lshlrev_b32 v118, 4, v118
    v_add_u32 v127, 0x10000, v4
    ds_write_b128 v4, v[98:101] offset:128
    ds_write_b128 v4, v[98:101] offset:16512
    ds_write_b128 v4, v[98:101] offset:32896
    ds_write_b128 v4, v[98:101] offset:49280
    ds_write_b128 v127, v[98:101] offset:128
    v_lshrrev_b32 v8, 2, v118
    v_lshlrev_b32 v9, 5, v118
    ds_write_b32 v8, v9 offset:0
    ds_write_b32 v8, v98 offset:64
    s_waitcnt lgkmcnt(0)
    s_barrier
    s_mov_b32 s58, 13046016
    s_mov_b32 s59, 0x20000
    s_lshl_b32 s39, s60, 12
    s_add_u32 s39, s39, 93824
    s_mov_b32 m0, s39
    v_add_u32 v113, s39, v83
    s_mov_b32 s95, 17301488
    s_mov_b32 s44, 82048
    s_mov_b32 s42, 512
    s_mov_b32 s65, 1
    s_mov_b32 s92, 1
    s_mov_b32 s83, -1
    s_mov_b32 s68, 0
    s_mov_b32 s69, 2048
    s_add_u32 s38, s64, 10485760
    s_add_u32 s39, s64, 10484736
    s_add_u32 s40, s64, 10483712
    s_add_u32 s41, s64, 10482688
    s_lshl_b32 s70, s61, 9
    v_lshrrev_b32 v88, 3, v1
    v_lshl_add_u32 v110, v88, 4, s70
    s_waitcnt vmcnt(2)
K2_REC:
    s_setprio 3
    v_cmp_ne_u32 s[78:79], -1, v3
    v_cmp_ne_u32 s[76:77], -1, v2
    v_mov_b32 v88, 4
    v_mov_b32 v89, 0x3f80
    v_and_b32 v44, 0x1c, v2
    s_cmp_lg_u64 s[78:79], 0
    s_cbranch_scc1 K2_R2
    s_mov_b64 exec, s[76:77]
    ds_add_rtn_u32 v42, v44, v88 offset:0
    v_and_b32 v40, 0x3fff00, v2
    v_lshrrev_b32 v85, 4, v40
    buffer_load_dwordx3 v[106:108], v85, s[52:55], s95 offen
    s_mov_b64 exec, -1
    v_bfe_u32 v46, v2, 5, 3
    v_lshl_add_u32 v86, v44, 7, s42
    v_lshlrev_b32 v48, 3, v46
    v_and_b32 v85, 0xfc, v2
    v_lshl_add_u32 v85, v85, 2, s44
    s_waitcnt lgkmcnt(0)
    v_cmp_gt_u32 vcc, v86, v42
    v_lshlrev_b32 v44, 2, v42
    v_lshl_add_u32 v46, v46, 1, v44
    s_and_b64 s[76:77], s[76:77], vcc
    s_mov_b64 exec, s[76:77]
    ds_write_b32 v42, v40 offset:41088
    ds_write_b16 v46, v89 offset:45184
    v_mad_u32_u24 v48, v42, 10, v48
    s_mov_b64 exec, -1
K2_R3:
    s_cmp_lg_u32 s92, 1
    s_cbranch_scc1 K2_B1
    s_mov_b32 s92, 0
    buffer_load_dword v50, v39, s[52:55], s43 offen offset:0
    buffer_load_dword v51, v39, s[52:55], s43 offen offset:256
    buffer_load_dword v52, v39, s[52:55], s43 offen offset:512
    buffer_load_dword v53, v39, s[52:55], s43 offen offset:768
    buffer_load_dword v54, v39, s[52:55], s43 offen offset:1024
    buffer_load_dword v55, v39, s[52:55], s43 offen offset:1280
    s_mov_b32 s70, 17039360
    buffer_load_dword v6, v10, s[52:55], s70 offen
    s_cmp_gt_u32 s60, 11
    s_cbranch_scc1 K2_B1
    s_waitcnt vmcnt(8)
    s_mov_b64 exec, s[90:91]
    ds_write_b128 v38, v[34:37]
    s_mov_b64 exec, -1
K2_B1:
    s_waitcnt lgkmcnt(0)
    s_barrier
    ds_read_b128 v[124:127], v110 offset:41088
    ds_read_b32 v40, v8 offset:0
    ds_read_b96 v[82:84], v85
    s_cmp_ge_u32 s60, 4
    s_cbranch_scc1 K2_C2
    s_waitcnt lgkmcnt(2)
    v_add_u32 v124, v124, v118
    v_add_u32 v125, v125, v118
    v_add_u32 v126, v126, v118
    v_add_u32 v127, v127, v118
    buffer_load_dwordx4 v124, s[56:59], s38 offen offset:0 lds
    buffer_load_dwordx4 v125, s[56:59], s39 offen offset:1024 lds
    buffer_load_dwordx4 v126, s[56:59], s40 offen offset:2048 lds
    buffer_load_dwordx4 v127, s[56:59], s41 offen offset:3072 lds
K2_C2:
    s_waitcnt lgkmcnt(1)
    v_sub_u32 v40, v40, v9
    v_cmp_lt_u32 vcc, s42, v40
    v_readlane_b32 s63, v40, s61
    s_cbranch_vccnz K2_RESTART
    s_lshr_b32 s63, s63, 2
    v_mov_b32 v5, 1
    v_mov_b32 v11, 64
    s_cmp_ge_u32 s60, 4
    s_cbranch_scc1 K2_C3
    s_waitcnt vmcnt(4) lgkmcnt(0)
    s_branch K2_C4
K2_C3:
    s_waitcnt vmcnt(0) lgkmcnt(0)
K2_C4:
    v_sub_f32 v82, v82, v106
    v_sub_f32 v83, v83, v107
    v_sub_f32 v84, v84, v108
    v_cvt_pk_bf16_f32 v16, 1.0, v82
    v_cvt_pk_bf16_f32 v17, v83, v84
    v_dot2_f32_bf16 v82, v16, v16, -1.0
    s_mov_b64 exec, s[76:77]
    v_dot2_f32_bf16 v82, v17, v17, v82
    ds_write_b64 v48, v[16:17] offset:128
    s_nop 1
    v_cvt_pk_bf16_f32 v14, v82, v82
    ds_write_b96 v44, v[12:14] offset:61568
    s_mov_b64 exec, -1
    s_cmp_eq_u64 s[78:79], 0
    s_cbranch_scc1 K2_G1
    ds_read_b96 v[82:84], v15
    s_waitcnt lgkmcnt(0)
    v_sub_f32 v82, v82, v98
    v_sub_f32 v83, v83, v99
    v_sub_f32 v84, v84, v100
    v_cvt_pk_bf16_f32 v16, 1.0, v82
    v_cvt_pk_bf16_f32 v17, v83, v84
    v_dot2_f32_bf16 v82, v16, v16, -1.0
    s_mov_b64 exec, s[78:79]
    v_dot2_f32_bf16 v82, v17, v17, v82
    ds_write_b64 v49, v[16:17] offset:128
    s_nop 1
    v_cvt_pk_bf16_f32 v104, v82, v82
    ds_write_b96 v45, v[102:104] offset:61568
    s_mov_b64 exec, -1
K2_G1:
    s_mov_b64 exec, 1
    s_waitcnt lgkmcnt(0)
    ds_add_u32 v11, v5
    s_mov_b64 exec, -1
    s_cmp_lt_u32 s60, 4
    s_cbranch_scc1 K2_C8
    v_add_u32 v124, v124, v118
    v_add_u32 v125, v125, v118
    v_add_u32 v126, v126, v118
    v_add_u32 v127, v127, v118
    buffer_load_dwordx4 v124, s[56:59], s38 offen offset:0 lds
    buffer_load_dwordx4 v125, s[56:59], s39 offen offset:1024 lds
    buffer_load_dwordx4 v126, s[56:59], s40 offen offset:2048 lds
    buffer_load_dwordx4 v127, s[56:59], s41 offen offset:3072 lds
K2_C8:
    s_cmp_eq_u32 s65, 0
    s_cbranch_scc1 K2_NOGEMM
    v_mov_b32 v97, 0
    v_mov_b32 v93, 0
    s_mov_b32 s66, 1.0
    s_mov_b32 s67, 1.0
    s_mov_b32 s80, 0xbfb8aa3b
    s_mov_b32 s81, 0xbf317218
    s_mov_b32 s86, -1
    s_mov_b32 s87, 0
    s_mov_b32 s93, 1
    s_mov_b32 s37, 272
    s_mov_b32 s82, 0xffff0000
    s_mov_b32 s88, 0x00ff00ff
    s_mov_b32 s89, 0x00ff00ff
    s_mov_b32 s50, 2620000
    s_mov_b32 s51, 0x20000
    v_lshrrev_b32 v85, 5, v1
    v_and_b32 v86, 31, v1
    v_lshlrev_b32 v87, 4, v86
    s_lshl_b32 s70, s61, 11
    s_add_u32 s70, s70, 45184
    v_lshl_add_u32 v111, v85, 14, v87
    v_add_u32 v111, s70, v111
    v_bfe_u32 v87, v1, 2, 2
    v_lshl_add_u32 v87, v85, 2, v87
    s_mul_i32 s70, s61, 5120
    v_mad_u32_u24 v112, v87, 40, s70
    v_bfe_u32 v87, v1, 4, 1
    v_lshl_add_u32 v112, v87, 5, v112
    v_and_b32 v87, 3, v1
    v_lshl_add_u32 v112, v87, 3, v112
    s_mov_b32 s70, 0x05040100
    s_mov_b32 s71, 0x07060302
    v_perm_b32 v94, v51, v50, s70
    v_perm_b32 v90, v51, v50, s71
    v_perm_b32 v95, v53, v52, s70
    v_perm_b32 v91, v53, v52, s71
    v_perm_b32 v96, v55, v54, s70
    v_perm_b32 v92, v55, v54, s71
    v_cmp_lt_u32 s[72:73], 0, v6
    v_cmp_lt_u32 vcc, 2048, v6
    s_mov_b64 s[74:75], vcc
K2_NOGEMM:
    s_nop 3
K2_POLL:
    ds_read_b32 v5, v11
    s_waitcnt lgkmcnt(0)
    v_readfirstlane_b32 s70, v5
    s_cmp_lt_u32 s70, 16
    s_nop 2
    s_cbranch_scc1 K2_POLL
    s_cmp_le_u32 s63, 0
    s_cbranch_scc1 K2_DONE
    s_setprio 2
    s_cmp_gt_u32 s63, 64
    s_cbranch_scc1 K2_PR_9
    s_setprio 1
    s_cmp_gt_u32 s63, 32
    s_cbranch_scc1 K2_PR_9
    s_setprio 0
K2_PR_9:
    ds_read_b128 v[98:101], v111 offset:0
    ds_read_b64_tr_b16 v[102:103], v112 offset:128
    ds_read_b64_tr_b16 v[104:105], v112 offset:448
    ds_read_b64_tr_b16 v[106:107], v112 offset:768
    ds_read_b64_tr_b16 v[108:109], v112 offset:1088
    s_sub_u32 s71, s63, 0
    s_cmp_le_u32 s71, 24
    s_cbranch_scc1 K2_TAIL
    ds_read_b128 v[124:127], v110 offset:41216
    s_waitcnt vmcnt(0)
    ds_read2st64_b32 v[2:3], v113 offset0:0 offset1:4
    ds_read2st64_b32 v[4:5], v113 offset0:8 offset1:12
    ds_read2st64_b32 v[6:7], v113 offset0:1 offset1:5
    ds_read2st64_b32 v[8:9], v113 offset0:9 offset1:13
    ds_read2st64_b32 v[10:11], v113 offset0:2 offset1:6
    ds_read2st64_b32 v[12:13], v113 offset0:10 offset1:14
    ds_read2st64_b32 v[14:15], v113 offset0:3 offset1:7
    ds_read2st64_b32 v[16:17], v113 offset0:11 offset1:15
    s_waitcnt lgkmcnt(7)
    v_lshlrev_b32 v34, 16, v2
    v_lshlrev_b32 v35, 16, v3
    s_waitcnt lgkmcnt(6)
    v_lshlrev_b32 v36, 16, v4
    v_lshlrev_b32 v37, 16, v5
    s_waitcnt lgkmcnt(5)
    v_lshlrev_b32 v38, 16, v6
    v_lshlrev_b32 v39, 16, v7
    s_waitcnt lgkmcnt(4)
    v_lshlrev_b32 v40, 16, v8
    v_lshlrev_b32 v41, 16, v9
    s_waitcnt lgkmcnt(3)
    v_lshlrev_b32 v42, 16, v10
    v_lshlrev_b32 v43, 16, v11
    s_waitcnt lgkmcnt(2)
    v_lshlrev_b32 v44, 16, v12
    v_lshlrev_b32 v45, 16, v13
    s_waitcnt lgkmcnt(1)
    v_lshlrev_b32 v46, 16, v14
    v_lshlrev_b32 v47, 16, v15
    s_waitcnt lgkmcnt(0)
    v_lshlrev_b32 v48, 16, v16
    v_lshlrev_b32 v49, 16, v17
    s_nop 1
    v_mfma_f32_32x32x16_bf16 v[34:49], v[98:101], v[94:97], v[34:49]
    s_cmp_le_u32 s63, 32
    s_cbranch_scc1 K2_G_10
    v_add_u32 v124, v124, v118
    v_add_u32 v125, v125, v118
    v_add_u32 v126, v126, v118
    v_add_u32 v127, v127, v118
    buffer_load_dwordx4 v124, s[56:59], s38 offen offset:0 lds
    buffer_load_dwordx4 v125, s[56:59], s39 offen offset:1024 lds
    buffer_load_dwordx4 v126, s[56:59], s40 offen offset:2048 lds
    buffer_load_dwordx4 v127, s[56:59], s41 offen offset:3072 lds
    s_branch K2_G_11
K2_G_10:
    s_nop 7
K2_G_11:
    v_mfma_f32_32x32x16_bf16 v[2:17], v[98:101], v[90:93], v[2:17]
    s_nop 0
    v_exp_f32 v82, v34
    v_exp_f32 v83, v35
    v_exp_f32 v84, v36
    v_exp_f32 v85, v37
    v_pk_add_f32 v[82:83], v[82:83], s[66:67]
    v_pk_add_f32 v[84:85], v[84:85], s[66:67]
    v_rcp_f32 v82, v82
    v_rcp_f32 v83, v83
    v_rcp_f32 v84, v84
    v_rcp_f32 v85, v85
    v_pk_mul_f32 v[82:83], v[82:83], v[34:35]
    v_pk_mul_f32 v[84:85], v[84:85], v[36:37]
    v_cvt_pk_bf16_f32 v34, v82, v83
    v_cvt_pk_bf16_f32 v35, v84, v85
    v_exp_f32 v82, v2
    v_exp_f32 v83, v3
    v_exp_f32 v84, v4
    v_exp_f32 v85, v5
    v_pk_add_f32 v[82:83], v[82:83], s[66:67]
    v_pk_add_f32 v[84:85], v[84:85], s[66:67]
    v_rcp_f32 v82, v82
    v_rcp_f32 v83, v83
    v_rcp_f32 v84, v84
    v_rcp_f32 v85, v85
    v_pk_mul_f32 v[82:83], v[82:83], v[2:3]
    v_pk_mul_f32 v[84:85], v[84:85], v[4:5]
    v_cvt_pk_bf16_f32 v2, v82, v83
    v_cvt_pk_bf16_f32 v3, v84, v85
    v_exp_f32 v82, v6
    v_exp_f32 v83, v7
    v_exp_f32 v84, v8
    v_exp_f32 v85, v9
    v_pk_add_f32 v[82:83], v[82:83], s[66:67]
    v_pk_add_f32 v[84:85], v[84:85], s[66:67]
    v_rcp_f32 v82, v82
    v_rcp_f32 v83, v83
    v_rcp_f32 v84, v84
    v_rcp_f32 v85, v85
    v_pk_mul_f32 v[82:83], v[82:83], v[6:7]
    v_pk_mul_f32 v[84:85], v[84:85], v[8:9]
    v_cvt_pk_bf16_f32 v4, v82, v83
    v_cvt_pk_bf16_f32 v5, v84, v85
    s_cmp_eq_u32 s93, 0
    s_cbranch_scc1 K2_Z_12
    v_mfma_f32_32x32x16_bf16 v[50:65], v[102:105], v[2:5], 0
    s_branch K2_Z_13
K2_Z_12:
    v_mfma_f32_32x32x16_bf16 v[50:65], v[102:105], v[2:5], v[50:65]
K2_Z_13:
    v_exp_f32 v82, v38
    v_exp_f32 v83, v39
    v_exp_f32 v84, v40
    v_exp_f32 v85, v41
    v_pk_add_f32 v[82:83], v[82:83], s[66:67]
    v_pk_add_f32 v[84:85], v[84:85], s[66:67]
    v_rcp_f32 v82, v82
    v_rcp_f32 v83, v83
    v_rcp_f32 v84, v84
    v_rcp_f32 v85, v85
    v_pk_mul_f32 v[82:83], v[82:83], v[38:39]
    v_pk_mul_f32 v[84:85], v[84:85], v[40:41]
    v_cvt_pk_bf16_f32 v36, v82, v83
    v_cvt_pk_bf16_f32 v37, v84, v85
    s_cmp_eq_u32 s93, 0
    s_cbranch_scc1 K2_Z_14
    v_mfma_f32_32x32x16_bf16 v[66:81], v[102:105], v[34:37], 0
    s_mov_b32 s93, 0
    s_branch K2_Z_15
K2_Z_14:
    v_mfma_f32_32x32x16_bf16 v[66:81], v[102:105], v[34:37], v[66:81]
K2_Z_15:
    v_exp_f32 v82, v10
    v_exp_f32 v83, v11
    v_exp_f32 v84, v12
    v_exp_f32 v85, v13
    v_exp_f32 v86, v42
    v_exp_f32 v87, v43
    v_exp_f32 v88, v44
    v_exp_f32 v89, v45
    v_pk_add_f32 v[82:83], v[82:83], s[66:67]
    v_pk_add_f32 v[84:85], v[84:85], s[66:67]
    v_pk_add_f32 v[86:87], v[86:87], s[66:67]
    v_pk_add_f32 v[88:89], v[88:89], s[66:67]
    v_rcp_f32 v82, v82
    v_rcp_f32 v83, v83
    v_rcp_f32 v84, v84
    v_rcp_f32 v85, v85
    v_rcp_f32 v86, v86
    v_rcp_f32 v87, v87
    v_rcp_f32 v88, v88
    v_rcp_f32 v89, v89
    v_pk_mul_f32 v[82:83], v[82:83], v[10:11]
    v_pk_mul_f32 v[84:85], v[84:85], v[12:13]
    v_pk_mul_f32 v[86:87], v[86:87], v[42:43]
    v_pk_mul_f32 v[88:89], v[88:89], v[44:45]
    v_cvt_pk_bf16_f32 v10, v82, v83
    v_cvt_pk_bf16_f32 v11, v84, v85
    v_cvt_pk_bf16_f32 v42, v86, v87
    v_cvt_pk_bf16_f32 v43, v88, v89
    v_exp_f32 v82, v14
    v_exp_f32 v83, v15
    v_exp_f32 v84, v16
    v_exp_f32 v85, v17
    v_pk_add_f32 v[82:83], v[82:83], s[66:67]
    v_pk_add_f32 v[84:85], v[84:85], s[66:67]
    v_rcp_f32 v82, v82
    v_rcp_f32 v83, v83
    v_rcp_f32 v84, v84
    v_rcp_f32 v85, v85
    v_pk_mul_f32 v[82:83], v[82:83], v[14:15]
    v_pk_mul_f32 v[84:85], v[84:85], v[16:17]
    v_cvt_pk_bf16_f32 v12, v82, v83
    v_cvt_pk_bf16_f32 v13, v84, v85
    s_nop 1
    v_mfma_f32_32x32x16_bf16 v[50:65], v[106:109], v[10:13], v[50:65]
    v_exp_f32 v82, v46
    v_exp_f32 v83, v47
    v_exp_f32 v84, v48
    v_exp_f32 v85, v49
    v_pk_add_f32 v[82:83], v[82:83], s[66:67]
    v_pk_add_f32 v[84:85], v[84:85], s[66:67]
    v_rcp_f32 v82, v82
    v_rcp_f32 v83, v83
    v_rcp_f32 v84, v84
    v_rcp_f32 v85, v85
    v_pk_mul_f32 v[82:83], v[82:83], v[46:47]
    v_pk_mul_f32 v[84:85], v[84:85], v[48:49]
    v_cvt_pk_bf16_f32 v44, v82, v83
    v_cvt_pk_bf16_f32 v45, v84, v85
    s_nop 1
    v_mfma_f32_32x32x16_bf16 v[66:81], v[106:109], v[42:45], v[66:81]
    s_cmp_le_u32 s63, 32
    s_cbranch_scc1 K2_DONE
    s_setprio 2
    s_cmp_gt_u32 s63, 96
    s_cbranch_scc1 K2_PR_16
    s_setprio 1
    s_cmp_gt_u32 s63, 64
    s_cbranch_scc1 K2_PR_16
    s_setprio 0
K2_PR_16:
    ds_read_b128 v[98:101], v111 offset:512
    ds_read_b64_tr_b16 v[102:103], v112 offset:1408
    ds_read_b64_tr_b16 v[104:105], v112 offset:1728
    ds_read_b64_tr_b16 v[106:107], v112 offset:2048
    ds_read_b64_tr_b16 v[108:109], v112 offset:2368
    s_sub_u32 s71, s63, 32
    s_cmp_le_u32 s71, 24
    s_cbranch_scc1 K2_TAIL
    ds_read_b128 v[124:127], v110 offset:41344
    s_waitcnt vmcnt(0)
    s_cmp_lg_u32 s65, 1
    s_cbranch_scc1 K2_W_17
    v_lshlrev_b32 v83, 4, v1
    s_and_b32 s36, s60, 7
    s_lshl_b32 s36, s36, 12
    s_add_u32 s36, s36, 16809984
    buffer_load_dwordx4 v[18:21], v83, s[52:55], s36 offen offset:0
    buffer_load_dwordx4 v[22:25], v83, s[52:55], s36 offen offset:1024
    buffer_load_dwordx4 v[26:29], v83, s[52:55], s36 offen offset:2048
    buffer_load_dwordx4 v[30:33], v83, s[52:55], s36 offen offset:3072
    s_add_u32 s36, s36, 32768
    s_mov_b32 s65, 2
K2_W_17:
    ds_read2st64_b32 v[2:3], v113 offset0:0 offset1:4
    ds_read2st64_b32 v[4:5], v113 offset0:8 offset1:12
    ds_read2st64_b32 v[6:7], v113 offset0:1 offset1:5
    ds_read2st64_b32 v[8:9], v113 offset0:9 offset1:13
    ds_read2st64_b32 v[10:11], v113 offset0:2 offset1:6
    ds_read2st64_b32 v[12:13], v113 offset0:10 offset1:14
    ds_read2st64_b32 v[14:15], v113 offset0:3 offset1:7
    ds_read2st64_b32 v[16:17], v113 offset0:11 offset1:15
    s_waitcnt lgkmcnt(7)
    v_lshlrev_b32 v34, 16, v2
    v_lshlrev_b32 v35, 16, v3
    s_waitcnt lgkmcnt(6)
    v_lshlrev_b32 v36, 16, v4
    v_lshlrev_b32 v37, 16, v5
    s_waitcnt lgkmcnt(5)
    v_lshlrev_b32 v38, 16, v6
    v_lshlrev_b32 v39, 16, v7
    s_waitcnt lgkmcnt(4)
    v_lshlrev_b32 v40, 16, v8
    v_lshlrev_b32 v41, 16, v9
    s_waitcnt lgkmcnt(3)
    v_lshlrev_b32 v42, 16, v10
    v_lshlrev_b32 v43, 16, v11
    s_waitcnt lgkmcnt(2)
    v_lshlrev_b32 v44, 16, v12
    v_lshlrev_b32 v45, 16, v13
    s_waitcnt lgkmcnt(1)
    v_lshlrev_b32 v46, 16, v14
    v_lshlrev_b32 v47, 16, v15
    s_waitcnt lgkmcnt(0)
    v_lshlrev_b32 v48, 16, v16
    v_lshlrev_b32 v49, 16, v17
    s_nop 1
    v_mfma_f32_32x32x16_bf16 v[34:49], v[98:101], v[94:97], v[34:49]
    s_cmp_le_u32 s63, 64
    s_cbranch_scc1 K2_G_18
    v_add_u32 v124, v124, v118
    v_add_u32 v125, v125, v118
    v_add_u32 v126, v126, v118
    v_add_u32 v127, v127, v118
    buffer_load_dwordx4 v124, s[56:59], s38 offen offset:0 lds
    buffer_load_dwordx4 v125, s[56:59], s39 offen offset:1024 lds
    buffer_load_dwordx4 v126, s[56:59], s40 offen offset:2048 lds
    buffer_load_dwordx4 v127, s[56:59], s41 offen offset:3072 lds
    s_branch K2_G_19
K2_G_18:
    s_nop 7
K2_G_19:
    v_mfma_f32_32x32x16_bf16 v[2:17], v[98:101], v[90:93], v[2:17]
    s_nop 0
    v_exp_f32 v82, v34
    v_exp_f32 v83, v35
    v_exp_f32 v84, v36
    v_exp_f32 v85, v37
    v_pk_add_f32 v[82:83], v[82:83], s[66:67]
    v_pk_add_f32 v[84:85], v[84:85], s[66:67]
    v_rcp_f32 v82, v82
    v_rcp_f32 v83, v83
    v_rcp_f32 v84, v84
    v_rcp_f32 v85, v85
    v_pk_mul_f32 v[82:83], v[82:83], v[34:35]
    v_pk_mul_f32 v[84:85], v[84:85], v[36:37]
    v_cvt_pk_bf16_f32 v34, v82, v83
    v_cvt_pk_bf16_f32 v35, v84, v85
    v_exp_f32 v82, v2
    v_exp_f32 v83, v3
    v_exp_f32 v84, v4
    v_exp_f32 v85, v5
    v_pk_add_f32 v[82:83], v[82:83], s[66:67]
    v_pk_add_f32 v[84:85], v[84:85], s[66:67]
    v_rcp_f32 v82, v82
    v_rcp_f32 v83, v83
    v_rcp_f32 v84, v84
    v_rcp_f32 v85, v85
    v_pk_mul_f32 v[82:83], v[82:83], v[2:3]
    v_pk_mul_f32 v[84:85], v[84:85], v[4:5]
    v_cvt_pk_bf16_f32 v2, v82, v83
    v_cvt_pk_bf16_f32 v3, v84, v85
    v_exp_f32 v82, v6
    v_exp_f32 v83, v7
    v_exp_f32 v84, v8
    v_exp_f32 v85, v9
    v_pk_add_f32 v[82:83], v[82:83], s[66:67]
    v_pk_add_f32 v[84:85], v[84:85], s[66:67]
    v_rcp_f32 v82, v82
    v_rcp_f32 v83, v83
    v_rcp_f32 v84, v84
    v_rcp_f32 v85, v85
    v_pk_mul_f32 v[82:83], v[82:83], v[6:7]
    v_pk_mul_f32 v[84:85], v[84:85], v[8:9]
    v_cvt_pk_bf16_f32 v4, v82, v83
    v_cvt_pk_bf16_f32 v5, v84, v85
    s_nop 1
    v_mfma_f32_32x32x16_bf16 v[50:65], v[102:105], v[2:5], v[50:65]
    v_exp_f32 v82, v38
    v_exp_f32 v83, v39
    v_exp_f32 v84, v40
    v_exp_f32 v85, v41
    v_pk_add_f32 v[82:83], v[82:83], s[66:67]
    v_pk_add_f32 v[84:85], v[84:85], s[66:67]
    v_rcp_f32 v82, v82
    v_rcp_f32 v83, v83
    v_rcp_f32 v84, v84
    v_rcp_f32 v85, v85
    v_pk_mul_f32 v[82:83], v[82:83], v[38:39]
    v_pk_mul_f32 v[84:85], v[84:85], v[40:41]
    v_cvt_pk_bf16_f32 v36, v82, v83
    v_cvt_pk_bf16_f32 v37, v84, v85
    s_nop 1
    v_mfma_f32_32x32x16_bf16 v[66:81], v[102:105], v[34:37], v[66:81]
    v_exp_f32 v82, v10
    v_exp_f32 v83, v11
    v_exp_f32 v84, v12
    v_exp_f32 v85, v13
    v_exp_f32 v86, v42
    v_exp_f32 v87, v43
    v_exp_f32 v88, v44
    v_exp_f32 v89, v45
    v_pk_add_f32 v[82:83], v[82:83], s[66:67]
    v_pk_add_f32 v[84:85], v[84:85], s[66:67]
    v_pk_add_f32 v[86:87], v[86:87], s[66:67]
    v_pk_add_f32 v[88:89], v[88:89], s[66:67]
    v_rcp_f32 v82, v82
    v_rcp_f32 v83, v83
    v_rcp_f32 v84, v84
    v_rcp_f32 v85, v85
    v_rcp_f32 v86, v86
    v_rcp_f32 v87, v87
    v_rcp_f32 v88, v88
    v_rcp_f32 v89, v89
    v_pk_mul_f32 v[82:83], v[82:83], v[10:11]
    v_pk_mul_f32 v[84:85], v[84:85], v[12:13]
    v_pk_mul_f32 v[86:87], v[86:87], v[42:43]
    v_pk_mul_f32 v[88:89], v[88:89], v[44:45]
    v_cvt_pk_bf16_f32 v10, v82, v83
    v_cvt_pk_bf16_f32 v11, v84, v85
    v_cvt_pk_bf16_f32 v42, v86, v87
    v_cvt_pk_bf16_f32 v43, v88, v89
    v_exp_f32 v82, v14
    v_exp_f32 v83, v15
    v_exp_f32 v84, v16
    v_exp_f32 v85, v17
    v_pk_add_f32 v[82:83], v[82:83], s[66:67]
    v_pk_add_f32 v[84:85], v[84:85], s[66:67]
    v_rcp_f32 v82, v82
    v_rcp_f32 v83, v83
    v_rcp_f32 v84, v84
    v_rcp_f32 v85, v85
    v_pk_mul_f32 v[82:83], v[82:83], v[14:15]
    v_pk_mul_f32 v[84:85], v[84:85], v[16:17]
    v_cvt_pk_bf16_f32 v12, v82, v83
    v_cvt_pk_bf16_f32 v13, v84, v85
    s_nop 1
    v_mfma_f32_32x32x16_bf16 v[50:65], v[106:109], v[10:13], v[50:65]
    v_exp_f32 v82, v46
    v_exp_f32 v83, v47
    v_exp_f32 v84, v48
    v_exp_f32 v85, v49
    v_pk_add_f32 v[82:83], v[82:83], s[66:67]
    v_pk_add_f32 v[84:85], v[84:85], s[66:67]
    v_rcp_f32 v82, v82
    v_rcp_f32 v83, v83
    v_rcp_f32 v84, v84
    v_rcp_f32 v85, v85
    v_pk_mul_f32 v[82:83], v[82:83], v[46:47]
    v_pk_mul_f32 v[84:85], v[84:85], v[48:49]
    v_cvt_pk_bf16_f32 v44, v82, v83
    v_cvt_pk_bf16_f32 v45, v84, v85
    s_nop 1
    v_mfma_f32_32x32x16_bf16 v[66:81], v[106:109], v[42:45], v[66:81]
    s_cmp_le_u32 s63, 64
    s_cbranch_scc1 K2_DONE
    s_setprio 1
    s_cmp_gt_u32 s63, 96
    s_cbranch_scc1 K2_PR_20
    s_setprio 0
K2_PR_20:
    ds_read_b128 v[98:101], v111 offset:1024
    ds_read_b64_tr_b16 v[102:103], v112 offset:2688
    ds_read_b64_tr_b16 v[104:105], v112 offset:3008
    ds_read_b64_tr_b16 v[106:107], v112 offset:3328
    ds_read_b64_tr_b16 v[108:109], v112 offset:3648
    s_sub_u32 s71, s63, 64
    s_cmp_le_u32 s71, 24
    s_cbranch_scc1 K2_TAIL
    ds_read_b128 v[124:127], v110 offset:41472
    s_waitcnt vmcnt(0)
    s_cmp_lg_u32 s65, 2
    s_cbranch_scc1 K2_W_21
    v_and_b32 v82, 15, v1
    v_and_b32 v83, 48, v1
    v_mad_u32_u24 v82, v82, s37, v83
    v_add_u32 v82, 82944, v82
    v_lshlrev_b32 v83, 4, v1
    s_cmp_ge_u32 s60, 8
    s_cbranch_scc1 K2_H_22
    ds_read_b128 v[34:37], v82 offset:4352
    ds_read_b128 v[38:41], v82 offset:4416
    ds_read_b128 v[42:45], v82 offset:4480
    ds_read_b128 v[46:49], v82 offset:4544
    ds_read_b128 v[2:5], v82 offset:0
    ds_read_b128 v[6:9], v82 offset:64
    ds_read_b128 v[10:13], v82 offset:128
    ds_read_b128 v[14:17], v82 offset:192
    s_waitcnt lgkmcnt(7)
    v_mfma_f32_16x16x32_bf16 v[114:117], v[18:21], v[34:37], 0
    s_waitcnt lgkmcnt(6)
    v_mfma_f32_16x16x32_bf16 v[114:117], v[22:25], v[38:41], v[114:117]
    s_waitcnt lgkmcnt(5)
    v_mfma_f32_16x16x32_bf16 v[114:117], v[26:29], v[42:45], v[114:117]
    s_waitcnt lgkmcnt(4)
    v_mfma_f32_16x16x32_bf16 v[114:117], v[30:33], v[46:49], v[114:117]
    s_branch K2_H_23
K2_H_22:
    ds_read_b128 v[2:5], v82 offset:8704
    ds_read_b128 v[6:9], v82 offset:8768
    ds_read_b128 v[10:13], v82 offset:8832
    ds_read_b128 v[14:17], v82 offset:8896
K2_H_23:
    s_waitcnt lgkmcnt(3)
    v_mfma_f32_16x16x32_bf16 v[120:123], v[18:21], v[2:5], 0
    s_waitcnt lgkmcnt(2)
    v_mfma_f32_16x16x32_bf16 v[120:123], v[22:25], v[6:9], v[120:123]
    s_waitcnt lgkmcnt(1)
    v_mfma_f32_16x16x32_bf16 v[120:123], v[26:29], v[10:13], v[120:123]
    s_waitcnt lgkmcnt(0)
    v_mfma_f32_16x16x32_bf16 v[120:123], v[30:33], v[14:17], v[120:123]
    buffer_load_dwordx4 v[18:21], v83, s[52:55], s36 offen offset:0
    buffer_load_dwordx4 v[22:25], v83, s[52:55], s36 offen offset:1024
    buffer_load_dwordx4 v[26:29], v83, s[52:55], s36 offen offset:2048
    buffer_load_dwordx4 v[30:33], v83, s[52:55], s36 offen offset:3072
    v_mul_f32 v114, s80, v114
    v_mul_f32 v115, s80, v115
    v_mul_f32 v116, s80, v116
    v_mul_f32 v117, s80, v117
    v_mul_f32 v120, s80, v120
    v_mul_f32 v121, s80, v121
    v_mul_f32 v122, s80, v122
    v_mul_f32 v123, s80, v123
    s_mov_b32 s65, 0
K2_W_21:
    ds_read2st64_b32 v[2:3], v113 offset0:0 offset1:4
    ds_read2st64_b32 v[4:5], v113 offset0:8 offset1:12
    ds_read2st64_b32 v[6:7], v113 offset0:1 offset1:5
    ds_read2st64_b32 v[8:9], v113 offset0:9 offset1:13
    ds_read2st64_b32 v[10:11], v113 offset0:2 offset1:6
    ds_read2st64_b32 v[12:13], v113 offset0:10 offset1:14
    ds_read2st64_b32 v[14:15], v113 offset0:3 offset1:7
    ds_read2st64_b32 v[16:17], v113 offset0:11 offset1:15
    s_waitcnt lgkmcnt(7)
    v_lshlrev_b32 v34, 16, v2
    v_lshlrev_b32 v35, 16, v3
    s_waitcnt lgkmcnt(6)
    v_lshlrev_b32 v36, 16, v4
    v_lshlrev_b32 v37, 16, v5
    s_waitcnt lgkmcnt(5)
    v_lshlrev_b32 v38, 16, v6
    v_lshlrev_b32 v39, 16, v7
    s_waitcnt lgkmcnt(4)
    v_lshlrev_b32 v40, 16, v8
    v_lshlrev_b32 v41, 16, v9
    s_waitcnt lgkmcnt(3)
    v_lshlrev_b32 v42, 16, v10
    v_lshlrev_b32 v43, 16, v11
    s_waitcnt lgkmcnt(2)
    v_lshlrev_b32 v44, 16, v12
    v_lshlrev_b32 v45, 16, v13
    s_waitcnt lgkmcnt(1)
    v_lshlrev_b32 v46, 16, v14
    v_lshlrev_b32 v47, 16, v15
    s_waitcnt lgkmcnt(0)
    v_lshlrev_b32 v48, 16, v16
    v_lshlrev_b32 v49, 16, v17
    s_nop 1
    v_mfma_f32_32x32x16_bf16 v[34:49], v[98:101], v[94:97], v[34:49]
    s_cmp_le_u32 s63, 96
    s_cbranch_scc1 K2_G_24
    v_add_u32 v124, v124, v118
    v_add_u32 v125, v125, v118
    v_add_u32 v126, v126, v118
    v_add_u32 v127, v127, v118
    buffer_load_dwordx4 v124, s[56:59], s38 offen offset:0 lds
    buffer_load_dwordx4 v125, s[56:59], s39 offen offset:1024 lds
    buffer_load_dwordx4 v126, s[56:59], s40 offen offset:2048 lds
    buffer_load_dwordx4 v127, s[56:59], s41 offen offset:3072 lds
    s_branch K2_G_25
K2_G_24:
    s_nop 7
K2_G_25:
    v_mfma_f32_32x32x16_bf16 v[2:17], v[98:101], v[90:93], v[2:17]
    s_nop 0
    v_exp_f32 v82, v34
    v_exp_f32 v83, v35
    v_exp_f32 v84, v36
    v_exp_f32 v85, v37
    v_pk_add_f32 v[82:83], v[82:83], s[66:67]
    v_pk_add_f32 v[84:85], v[84:85], s[66:67]
    v_rcp_f32 v82, v82
    v_rcp_f32 v83, v83
    v_rcp_f32 v84, v84
    v_rcp_f32 v85, v85
    v_pk_mul_f32 v[82:83], v[82:83], v[34:35]
    v_pk_mul_f32 v[84:85], v[84:85], v[36:37]
    v_cvt_pk_bf16_f32 v34, v82, v83
    v_cvt_pk_bf16_f32 v35, v84, v85
    v_exp_f32 v82, v2
    v_exp_f32 v83, v3
    v_exp_f32 v84, v4
    v_exp_f32 v85, v5
    v_pk_add_f32 v[82:83], v[82:83], s[66:67]
    v_pk_add_f32 v[84:85], v[84:85], s[66:67]
    v_rcp_f32 v82, v82
    v_rcp_f32 v83, v83
    v_rcp_f32 v84, v84
    v_rcp_f32 v85, v85
    v_pk_mul_f32 v[82:83], v[82:83], v[2:3]
    v_pk_mul_f32 v[84:85], v[84:85], v[4:5]
    v_cvt_pk_bf16_f32 v2, v82, v83
    v_cvt_pk_bf16_f32 v3, v84, v85
    v_exp_f32 v82, v6
    v_exp_f32 v83, v7
    v_exp_f32 v84, v8
    v_exp_f32 v85, v9
    v_pk_add_f32 v[82:83], v[82:83], s[66:67]
    v_pk_add_f32 v[84:85], v[84:85], s[66:67]
    v_rcp_f32 v82, v82
    v_rcp_f32 v83, v83
    v_rcp_f32 v84, v84
    v_rcp_f32 v85, v85
    v_pk_mul_f32 v[82:83], v[82:83], v[6:7]
    v_pk_mul_f32 v[84:85], v[84:85], v[8:9]
    v_cvt_pk_bf16_f32 v4, v82, v83
    v_cvt_pk_bf16_f32 v5, v84, v85
    s_nop 1
    v_mfma_f32_32x32x16_bf16 v[50:65], v[102:105], v[2:5], v[50:65]
    v_exp_f32 v82, v38
    v_exp_f32 v83, v39
    v_exp_f32 v84, v40
    v_exp_f32 v85, v41
    v_pk_add_f32 v[82:83], v[82:83], s[66:67]
    v_pk_add_f32 v[84:85], v[84:85], s[66:67]
    v_rcp_f32 v82, v82
    v_rcp_f32 v83, v83
    v_rcp_f32 v84, v84
    v_rcp_f32 v85, v85
    v_pk_mul_f32 v[82:83], v[82:83], v[38:39]
    v_pk_mul_f32 v[84:85], v[84:85], v[40:41]
    v_cvt_pk_bf16_f32 v36, v82, v83
    v_cvt_pk_bf16_f32 v37, v84, v85
    s_nop 1
    v_mfma_f32_32x32x16_bf16 v[66:81], v[102:105], v[34:37], v[66:81]
    v_exp_f32 v82, v10
    v_exp_f32 v83, v11
    v_exp_f32 v84, v12
    v_exp_f32 v85, v13
    v_exp_f32 v86, v42
    v_exp_f32 v87, v43
    v_exp_f32 v88, v44
    v_exp_f32 v89, v45
    v_pk_add_f32 v[82:83], v[82:83], s[66:67]
    v_pk_add_f32 v[84:85], v[84:85], s[66:67]
    v_pk_add_f32 v[86:87], v[86:87], s[66:67]
    v_pk_add_f32 v[88:89], v[88:89], s[66:67]
    v_rcp_f32 v82, v82
    v_rcp_f32 v83, v83
    v_rcp_f32 v84, v84
    v_rcp_f32 v85, v85
    v_rcp_f32 v86, v86
    v_rcp_f32 v87, v87
    v_rcp_f32 v88, v88
    v_rcp_f32 v89, v89
    v_pk_mul_f32 v[82:83], v[82:83], v[10:11]
    v_pk_mul_f32 v[84:85], v[84:85], v[12:13]
    v_pk_mul_f32 v[86:87], v[86:87], v[42:43]
    v_pk_mul_f32 v[88:89], v[88:89], v[44:45]
    v_cvt_pk_bf16_f32 v10, v82, v83
    v_cvt_pk_bf16_f32 v11, v84, v85
    v_cvt_pk_bf16_f32 v42, v86, v87
    v_cvt_pk_bf16_f32 v43, v88, v89
    v_exp_f32 v82, v14
    v_exp_f32 v83, v15
    v_exp_f32 v84, v16
    v_exp_f32 v85, v17
    v_pk_add_f32 v[82:83], v[82:83], s[66:67]
    v_pk_add_f32 v[84:85], v[84:85], s[66:67]
    v_rcp_f32 v82, v82
    v_rcp_f32 v83, v83
    v_rcp_f32 v84, v84
    v_rcp_f32 v85, v85
    v_pk_mul_f32 v[82:83], v[82:83], v[14:15]
    v_pk_mul_f32 v[84:85], v[84:85], v[16:17]
    v_cvt_pk_bf16_f32 v12, v82, v83
    v_cvt_pk_bf16_f32 v13, v84, v85
    s_nop 1
    v_mfma_f32_32x32x16_bf16 v[50:65], v[106:109], v[10:13], v[50:65]
    v_exp_f32 v82, v46
    v_exp_f32 v83, v47
    v_exp_f32 v84, v48
    v_exp_f32 v85, v49
    v_pk_add_f32 v[82:83], v[82:83], s[66:67]
    v_pk_add_f32 v[84:85], v[84:85], s[66:67]
    v_rcp_f32 v82, v82
    v_rcp_f32 v83, v83
    v_rcp_f32 v84, v84
    v_rcp_f32 v85, v85
    v_pk_mul_f32 v[82:83], v[82:83], v[46:47]
    v_pk_mul_f32 v[84:85], v[84:85], v[48:49]
    v_cvt_pk_bf16_f32 v44, v82, v83
    v_cvt_pk_bf16_f32 v45, v84, v85
    s_nop 1
    v_mfma_f32_32x32x16_bf16 v[66:81], v[106:109], v[42:45], v[66:81]
    s_cmp_le_u32 s63, 96
    s_cbranch_scc1 K2_DONE
    s_setprio 0
K2_PR_26:
    ds_read_b128 v[98:101], v111 offset:1536
    ds_read_b64_tr_b16 v[102:103], v112 offset:3968
    ds_read_b64_tr_b16 v[104:105], v112 offset:4288
    ds_read_b64_tr_b16 v[106:107], v112 offset:4608
    ds_read_b64_tr_b16 v[108:109], v112 offset:4928
    s_sub_u32 s71, s63, 96
    s_cmp_le_u32 s71, 24
    s_cbranch_scc1 K2_TAIL
    s_waitcnt vmcnt(0)
    ds_read2st64_b32 v[2:3], v113 offset0:0 offset1:4
    ds_read2st64_b32 v[4:5], v113 offset0:8 offset1:12
    ds_read2st64_b32 v[6:7], v113 offset0:1 offset1:5
    ds_read2st64_b32 v[8:9], v113 offset0:9 offset1:13
    ds_read2st64_b32 v[10:11], v113 offset0:2 offset1:6
    ds_read2st64_b32 v[12:13], v113 offset0:10 offset1:14
    ds_read2st64_b32 v[14:15], v113 offset0:3 offset1:7
    ds_read2st64_b32 v[16:17], v113 offset0:11 offset1:15
    s_waitcnt lgkmcnt(7)
    v_lshlrev_b32 v34, 16, v2
    v_lshlrev_b32 v35, 16, v3
    s_waitcnt lgkmcnt(6)
    v_lshlrev_b32 v36, 16, v4
    v_lshlrev_b32 v37, 16, v5
    s_waitcnt lgkmcnt(5)
    v_lshlrev_b32 v38, 16, v6
    v_lshlrev_b32 v39, 16, v7
    s_waitcnt lgkmcnt(4)
    v_lshlrev_b32 v40, 16, v8
    v_lshlrev_b32 v41, 16, v9
    s_waitcnt lgkmcnt(3)
    v_lshlrev_b32 v42, 16, v10
    v_lshlrev_b32 v43, 16, v11
    s_waitcnt lgkmcnt(2)
    v_lshlrev_b32 v44, 16, v12
    v_lshlrev_b32 v45, 16, v13
    s_waitcnt lgkmcnt(1)
    v_lshlrev_b32 v46, 16, v14
    v_lshlrev_b32 v47, 16, v15
    s_waitcnt lgkmcnt(0)
    v_lshlrev_b32 v48, 16, v16
    v_lshlrev_b32 v49, 16, v17
    s_nop 1
    v_mfma_f32_32x32x16_bf16 v[34:49], v[98:101], v[94:97], v[34:49]
    s_nop 7
    v_mfma_f32_32x32x16_bf16 v[2:17], v[98:101], v[90:93], v[2:17]
    s_nop 2
    v_exp_f32 v82, v34
    v_exp_f32 v83, v35
    v_exp_f32 v84, v36
    v_exp_f32 v85, v37
    v_pk_add_f32 v[82:83], v[82:83], s[66:67]
    v_pk_add_f32 v[84:85], v[84:85], s[66:67]
    v_rcp_f32 v82, v82
    v_rcp_f32 v83, v83
    v_rcp_f32 v84, v84
    v_rcp_f32 v85, v85
    v_pk_mul_f32 v[82:83], v[82:83], v[34:35]
    v_pk_mul_f32 v[84:85], v[84:85], v[36:37]
    v_cvt_pk_bf16_f32 v34, v82, v83
    v_cvt_pk_bf16_f32 v35, v84, v85
    v_exp_f32 v82, v2
    v_exp_f32 v83, v3
    v_exp_f32 v84, v4
    v_exp_f32 v85, v5
    v_pk_add_f32 v[82:83], v[82:83], s[66:67]
    v_pk_add_f32 v[84:85], v[84:85], s[66:67]
    v_rcp_f32 v82, v82
    v_rcp_f32 v83, v83
    v_rcp_f32 v84, v84
    v_rcp_f32 v85, v85
    v_pk_mul_f32 v[82:83], v[82:83], v[2:3]
    v_pk_mul_f32 v[84:85], v[84:85], v[4:5]
    v_cvt_pk_bf16_f32 v2, v82, v83
    v_cvt_pk_bf16_f32 v3, v84, v85
    v_exp_f32 v82, v6
    v_exp_f32 v83, v7
    v_exp_f32 v84, v8
    v_exp_f32 v85, v9
    v_pk_add_f32 v[82:83], v[82:83], s[66:67]
    v_pk_add_f32 v[84:85], v[84:85], s[66:67]
    v_rcp_f32 v82, v82
    v_rcp_f32 v83, v83
    v_rcp_f32 v84, v84
    v_rcp_f32 v85, v85
    v_pk_mul_f32 v[82:83], v[82:83], v[6:7]
    v_pk_mul_f32 v[84:85], v[84:85], v[8:9]
    v_cvt_pk_bf16_f32 v4, v82, v83
    v_cvt_pk_bf16_f32 v5, v84, v85
    s_nop 1
    v_mfma_f32_32x32x16_bf16 v[50:65], v[102:105], v[2:5], v[50:65]
    v_exp_f32 v82, v38
    v_exp_f32 v83, v39
    v_exp_f32 v84, v40
    v_exp_f32 v85, v41
    v_pk_add_f32 v[82:83], v[82:83], s[66:67]
    v_pk_add_f32 v[84:85], v[84:85], s[66:67]
    v_rcp_f32 v82, v82
    v_rcp_f32 v83, v83
    v_rcp_f32 v84, v84
    v_rcp_f32 v85, v85
    v_pk_mul_f32 v[82:83], v[82:83], v[38:39]
    v_pk_mul_f32 v[84:85], v[84:85], v[40:41]
    v_cvt_pk_bf16_f32 v36, v82, v83
    v_cvt_pk_bf16_f32 v37, v84, v85
    s_nop 1
    v_mfma_f32_32x32x16_bf16 v[66:81], v[102:105], v[34:37], v[66:81]
    v_exp_f32 v82, v10
    v_exp_f32 v83, v11
    v_exp_f32 v84, v12
    v_exp_f32 v85, v13
    v_exp_f32 v86, v42
    v_exp_f32 v87, v43
    v_exp_f32 v88, v44
    v_exp_f32 v89, v45
    v_pk_add_f32 v[82:83], v[82:83], s[66:67]
    v_pk_add_f32 v[84:85], v[84:85], s[66:67]
    v_pk_add_f32 v[86:87], v[86:87], s[66:67]
    v_pk_add_f32 v[88:89], v[88:89], s[66:67]
    v_rcp_f32 v82, v82
    v_rcp_f32 v83, v83
    v_rcp_f32 v84, v84
    v_rcp_f32 v85, v85
    v_rcp_f32 v86, v86
    v_rcp_f32 v87, v87
    v_rcp_f32 v88, v88
    v_rcp_f32 v89, v89
    v_pk_mul_f32 v[82:83], v[82:83], v[10:11]
    v_pk_mul_f32 v[84:85], v[84:85], v[12:13]
    v_pk_mul_f32 v[86:87], v[86:87], v[42:43]
    v_pk_mul_f32 v[88:89], v[88:89], v[44:45]
    v_cvt_pk_bf16_f32 v10, v82, v83
    v_cvt_pk_bf16_f32 v11, v84, v85
    v_cvt_pk_bf16_f32 v42, v86, v87
    v_cvt_pk_bf16_f32 v43, v88, v89
    v_exp_f32 v82, v14
    v_exp_f32 v83, v15
    v_exp_f32 v84, v16
    v_exp_f32 v85, v17
    v_pk_add_f32 v[82:83], v[82:83], s[66:67]
    v_pk_add_f32 v[84:85], v[84:85], s[66:67]
    v_rcp_f32 v82, v82
    v_rcp_f32 v83, v83
    v_rcp_f32 v84, v84
    v_rcp_f32 v85, v85
    v_pk_mul_f32 v[82:83], v[82:83], v[14:15]
    v_pk_mul_f32 v[84:85], v[84:85], v[16:17]
    v_cvt_pk_bf16_f32 v12, v82, v83
    v_cvt_pk_bf16_f32 v13, v84, v85
    s_nop 1
    v_mfma_f32_32x32x16_bf16 v[50:65], v[106:109], v[10:13], v[50:65]
    v_exp_f32 v82, v46
    v_exp_f32 v83, v47
    v_exp_f32 v84, v48
    v_exp_f32 v85, v49
    v_pk_add_f32 v[82:83], v[82:83], s[66:67]
    v_pk_add_f32 v[84:85], v[84:85], s[66:67]
    v_rcp_f32 v82, v82
    v_rcp_f32 v83, v83
    v_rcp_f32 v84, v84
    v_rcp_f32 v85, v85
    v_pk_mul_f32 v[82:83], v[82:83], v[46:47]
    v_pk_mul_f32 v[84:85], v[84:85], v[48:49]
    v_cvt_pk_bf16_f32 v44, v82, v83
    v_cvt_pk_bf16_f32 v45, v84, v85
    s_nop 1
    v_mfma_f32_32x32x16_bf16 v[66:81], v[106:109], v[42:45], v[66:81]
    s_branch K2_DONE
K2_TAIL:
    s_waitcnt vmcnt(0)
    s_cmp_lg_u32 s65, 2
    s_cbranch_scc1 K2_W_27
    v_and_b32 v82, 15, v1
    v_and_b32 v83, 48, v1
    v_mad_u32_u24 v82, v82, s37, v83
    v_add_u32 v82, 82944, v82
    v_lshlrev_b32 v83, 4, v1
    s_cmp_ge_u32 s60, 8
    s_cbranch_scc1 K2_H_28
    ds_read_b128 v[34:37], v82 offset:4352
    ds_read_b128 v[38:41], v82 offset:4416
    ds_read_b128 v[42:45], v82 offset:4480
    ds_read_b128 v[46:49], v82 offset:4544
    ds_read_b128 v[2:5], v82 offset:0
    ds_read_b128 v[6:9], v82 offset:64
    ds_read_b128 v[10:13], v82 offset:128
    ds_read_b128 v[14:17], v82 offset:192
    s_waitcnt lgkmcnt(7)
    v_mfma_f32_16x16x32_bf16 v[114:117], v[18:21], v[34:37], 0
    s_waitcnt lgkmcnt(6)
    v_mfma_f32_16x16x32_bf16 v[114:117], v[22:25], v[38:41], v[114:117]
    s_waitcnt lgkmcnt(5)
    v_mfma_f32_16x16x32_bf16 v[114:117], v[26:29], v[42:45], v[114:117]
    s_waitcnt lgkmcnt(4)
    v_mfma_f32_16x16x32_bf16 v[114:117], v[30:33], v[46:49], v[114:117]
    s_branch K2_H_29
K2_H_28:
    ds_read_b128 v[2:5], v82 offset:8704
    ds_read_b128 v[6:9], v82 offset:8768
    ds_read_b128 v[10:13], v82 offset:8832
    ds_read_b128 v[14:17], v82 offset:8896
K2_H_29:
    s_waitcnt lgkmcnt(3)
    v_mfma_f32_16x16x32_bf16 v[120:123], v[18:21], v[2:5], 0
    s_waitcnt lgkmcnt(2)
    v_mfma_f32_16x16x32_bf16 v[120:123], v[22:25], v[6:9], v[120:123]
    s_waitcnt lgkmcnt(1)
    v_mfma_f32_16x16x32_bf16 v[120:123], v[26:29], v[10:13], v[120:123]
    s_waitcnt lgkmcnt(0)
    v_mfma_f32_16x16x32_bf16 v[120:123], v[30:33], v[14:17], v[120:123]
    buffer_load_dwordx4 v[18:21], v83, s[52:55], s36 offen offset:0
    buffer_load_dwordx4 v[22:25], v83, s[52:55], s36 offen offset:1024
    buffer_load_dwordx4 v[26:29], v83, s[52:55], s36 offen offset:2048
    buffer_load_dwordx4 v[30:33], v83, s[52:55], s36 offen offset:3072
    v_mul_f32 v114, s80, v114
    v_mul_f32 v115, s80, v115
    v_mul_f32 v116, s80, v116
    v_mul_f32 v117, s80, v117
    v_mul_f32 v120, s80, v120
    v_mul_f32 v121, s80, v121
    v_mul_f32 v122, s80, v122
    v_mul_f32 v123, s80, v123
    s_mov_b32 s65, 0
K2_W_27:
    ds_read2st64_b32 v[2:3], v113 offset0:0 offset1:4
    ds_read2st64_b32 v[4:5], v113 offset0:8 offset1:12
    s_cmp_le_u32 s71, 8
    s_cbranch_scc1 K2_T_30
    ds_read2st64_b32 v[6:7], v113 offset0:1 offset1:5
    ds_read2st64_b32 v[8:9], v113 offset0:9 offset1:13
    s_cmp_le_u32 s71, 16
    s_cbranch_scc1 K2_T_30
    ds_read2st64_b32 v[10:11], v113 offset0:2 offset1:6
    ds_read2st64_b32 v[12:13], v113 offset0:10 offset1:14
K2_T_30:
    s_waitcnt lgkmcnt(0)
    v_lshlrev_b32 v34, 16, v2
    v_lshlrev_b32 v35, 16, v3
    v_lshlrev_b32 v36, 16, v4
    v_lshlrev_b32 v37, 16, v5
    s_cmp_le_u32 s71, 8
    s_cbranch_scc1 K2_T_31
    v_lshlrev_b32 v38, 16, v6
    v_lshlrev_b32 v39, 16, v7
    v_lshlrev_b32 v40, 16, v8
    v_lshlrev_b32 v41, 16, v9
    s_cmp_le_u32 s71, 16
    s_cbranch_scc1 K2_T_31
    v_lshlrev_b32 v42, 16, v10
    v_lshlrev_b32 v43, 16, v11
    v_lshlrev_b32 v44, 16, v12
    v_lshlrev_b32 v45, 16, v13
K2_T_31:
    s_nop 1
    v_mfma_f32_32x32x16_bf16 v[34:49], v[98:101], v[94:97], v[34:49]
    s_nop 7
    v_mfma_f32_32x32x16_bf16 v[2:17], v[98:101], v[90:93], v[2:17]
    s_nop 2
    v_exp_f32 v82, v34
    v_exp_f32 v83, v35
    v_exp_f32 v84, v36
    v_exp_f32 v85, v37
    v_pk_add_f32 v[82:83], v[82:83], s[66:67]
    v_pk_add_f32 v[84:85], v[84:85], s[66:67]
    v_rcp_f32 v82, v82
    v_rcp_f32 v83, v83
    v_rcp_f32 v84, v84
    v_rcp_f32 v85, v85
    v_pk_mul_f32 v[82:83], v[82:83], v[34:35]
    v_pk_mul_f32 v[84:85], v[84:85], v[36:37]
    v_cvt_pk_bf16_f32 v34, v82, v83
    v_cvt_pk_bf16_f32 v35, v84, v85
    v_exp_f32 v82, v2
    v_exp_f32 v83, v3
    v_exp_f32 v84, v4
    v_exp_f32 v85, v5
    v_pk_add_f32 v[82:83], v[82:83], s[66:67]
    v_pk_add_f32 v[84:85], v[84:85], s[66:67]
    v_rcp_f32 v82, v82
    v_rcp_f32 v83, v83
    v_rcp_f32 v84, v84
    v_rcp_f32 v85, v85
    v_pk_mul_f32 v[82:83], v[82:83], v[2:3]
    v_pk_mul_f32 v[84:85], v[84:85], v[4:5]
    v_cvt_pk_bf16_f32 v2, v82, v83
    v_cvt_pk_bf16_f32 v3, v84, v85
    s_cmp_le_u32 s71, 8
    s_cbranch_scc1 K2_O_32
    v_exp_f32 v82, v6
    v_exp_f32 v83, v7
    v_exp_f32 v84, v8
    v_exp_f32 v85, v9
    v_pk_add_f32 v[82:83], v[82:83], s[66:67]
    v_pk_add_f32 v[84:85], v[84:85], s[66:67]
    v_rcp_f32 v82, v82
    v_rcp_f32 v83, v83
    v_rcp_f32 v84, v84
    v_rcp_f32 v85, v85
    v_pk_mul_f32 v[82:83], v[82:83], v[6:7]
    v_pk_mul_f32 v[84:85], v[84:85], v[8:9]
    v_cvt_pk_bf16_f32 v4, v82, v83
    v_cvt_pk_bf16_f32 v5, v84, v85
    s_cmp_eq_u32 s93, 0
    s_cbranch_scc1 K2_Z_33
    v_mfma_f32_32x32x16_bf16 v[50:65], v[102:105], v[2:5], 0
    s_branch K2_Z_34
K2_Z_33:
    v_mfma_f32_32x32x16_bf16 v[50:65], v[102:105], v[2:5], v[50:65]
K2_Z_34:
    v_exp_f32 v82, v38
    v_exp_f32 v83, v39
    v_exp_f32 v84, v40
    v_exp_f32 v85, v41
    v_pk_add_f32 v[82:83], v[82:83], s[66:67]
    v_pk_add_f32 v[84:85], v[84:85], s[66:67]
    v_rcp_f32 v82, v82
    v_rcp_f32 v83, v83
    v_rcp_f32 v84, v84
    v_rcp_f32 v85, v85
    v_pk_mul_f32 v[82:83], v[82:83], v[38:39]
    v_pk_mul_f32 v[84:85], v[84:85], v[40:41]
    v_cvt_pk_bf16_f32 v36, v82, v83
    v_cvt_pk_bf16_f32 v37, v84, v85
    s_cmp_eq_u32 s93, 0
    s_cbranch_scc1 K2_Z_35
    v_mfma_f32_32x32x16_bf16 v[66:81], v[102:105], v[34:37], 0
    s_mov_b32 s93, 0
    s_branch K2_Z_36
K2_Z_35:
    v_mfma_f32_32x32x16_bf16 v[66:81], v[102:105], v[34:37], v[66:81]
K2_Z_36:
    s_cmp_le_u32 s71, 16
    s_cbranch_scc1 K2_DONE
    v_exp_f32 v82, v10
    v_exp_f32 v83, v11
    v_exp_f32 v84, v12
    v_exp_f32 v85, v13
    v_exp_f32 v86, v42
    v_exp_f32 v87, v43
    v_exp_f32 v88, v44
    v_exp_f32 v89, v45
    v_pk_add_f32 v[82:83], v[82:83], s[66:67]
    v_pk_add_f32 v[84:85], v[84:85], s[66:67]
    v_pk_add_f32 v[86:87], v[86:87], s[66:67]
    v_pk_add_f32 v[88:89], v[88:89], s[66:67]
    v_rcp_f32 v82, v82
    v_rcp_f32 v83, v83
    v_rcp_f32 v84, v84
    v_rcp_f32 v85, v85
    v_rcp_f32 v86, v86
    v_rcp_f32 v87, v87
    v_rcp_f32 v88, v88
    v_rcp_f32 v89, v89
    v_pk_mul_f32 v[82:83], v[82:83], v[10:11]
    v_pk_mul_f32 v[84:85], v[84:85], v[12:13]
    v_pk_mul_f32 v[86:87], v[86:87], v[42:43]
    v_pk_mul_f32 v[88:89], v[88:89], v[44:45]
    v_cvt_pk_bf16_f32 v10, v82, v83
    v_cvt_pk_bf16_f32 v11, v84, v85
    v_cvt_pk_bf16_f32 v42, v86, v87
    v_cvt_pk_bf16_f32 v43, v88, v89
    v_mov_b32 v12, 0
    v_mov_b32 v13, 0
    v_mov_b32 v44, 0
    v_mov_b32 v45, 0
    v_mfma_f32_32x32x16_bf16 v[50:65], v[106:109], v[10:13], v[50:65]
    s_nop 0
    v_mfma_f32_32x32x16_bf16 v[66:81], v[106:109], v[42:45], v[66:81]
    s_branch K2_DONE
K2_O_32:
    v_mov_b32 v4, 0
    v_mov_b32 v5, 0
    v_mov_b32 v36, 0
    v_mov_b32 v37, 0
    s_cmp_eq_u32 s93, 0
    s_cbranch_scc1 K2_Z_37
    v_mfma_f32_32x32x16_bf16 v[50:65], v[102:105], v[2:5], 0
    s_branch K2_Z_38
K2_Z_37:
    v_mfma_f32_32x32x16_bf16 v[50:65], v[102:105], v[2:5], v[50:65]
K2_Z_38:
    s_cmp_eq_u32 s93, 0
    s_cbranch_scc1 K2_Z_39
    v_mfma_f32_32x32x16_bf16 v[66:81], v[102:105], v[34:37], 0
    s_mov_b32 s93, 0
    s_branch K2_Z_40
K2_Z_39:
    v_mfma_f32_32x32x16_bf16 v[66:81], v[102:105], v[34:37], v[66:81]
K2_Z_40:
K2_DONE:
    s_setprio 3
    s_waitcnt vmcnt(0)
    s_cmp_eq_u32 s65, 0
    s_cbranch_scc1 K2_D1
    s_cmp_lg_u32 s65, 1
    s_cbranch_scc1 K2_W_41
    v_lshlrev_b32 v83, 4, v1
    s_and_b32 s36, s60, 7
    s_lshl_b32 s36, s36, 12
    s_add_u32 s36, s36, 16809984
    buffer_load_dwordx4 v[18:21], v83, s[52:55], s36 offen offset:0
    buffer_load_dwordx4 v[22:25], v83, s[52:55], s36 offen offset:1024
    buffer_load_dwordx4 v[26:29], v83, s[52:55], s36 offen offset:2048
    buffer_load_dwordx4 v[30:33], v83, s[52:55], s36 offen offset:3072
    s_add_u32 s36, s36, 32768
    s_mov_b32 s65, 2
K2_W_41:
    s_waitcnt vmcnt(0)
    v_and_b32 v82, 15, v1
    v_and_b32 v83, 48, v1
    v_mad_u32_u24 v82, v82, s37, v83
    v_add_u32 v82, 82944, v82
    v_lshlrev_b32 v83, 4, v1
    s_cmp_ge_u32 s60, 8
    s_cbranch_scc1 K2_H_42
    ds_read_b128 v[34:37], v82 offset:4352
    ds_read_b128 v[38:41], v82 offset:4416
    ds_read_b128 v[42:45], v82 offset:4480
    ds_read_b128 v[46:49], v82 offset:4544
    ds_read_b128 v[2:5], v82 offset:0
    ds_read_b128 v[6:9], v82 offset:64
    ds_read_b128 v[10:13], v82 offset:128
    ds_read_b128 v[14:17], v82 offset:192
    s_waitcnt lgkmcnt(7)
    v_mfma_f32_16x16x32_bf16 v[114:117], v[18:21], v[34:37], 0
    s_waitcnt lgkmcnt(6)
    v_mfma_f32_16x16x32_bf16 v[114:117], v[22:25], v[38:41], v[114:117]
    s_waitcnt lgkmcnt(5)
    v_mfma_f32_16x16x32_bf16 v[114:117], v[26:29], v[42:45], v[114:117]
    s_waitcnt lgkmcnt(4)
    v_mfma_f32_16x16x32_bf16 v[114:117], v[30:33], v[46:49], v[114:117]
    s_branch K2_H_43
K2_H_42:
    ds_read_b128 v[2:5], v82 offset:8704
    ds_read_b128 v[6:9], v82 offset:8768
    ds_read_b128 v[10:13], v82 offset:8832
    ds_read_b128 v[14:17], v82 offset:8896
K2_H_43:
    s_waitcnt lgkmcnt(3)
    v_mfma_f32_16x16x32_bf16 v[120:123], v[18:21], v[2:5], 0
    s_waitcnt lgkmcnt(2)
    v_mfma_f32_16x16x32_bf16 v[120:123], v[22:25], v[6:9], v[120:123]
    s_waitcnt lgkmcnt(1)
    v_mfma_f32_16x16x32_bf16 v[120:123], v[26:29], v[10:13], v[120:123]
    s_waitcnt lgkmcnt(0)
    v_mfma_f32_16x16x32_bf16 v[120:123], v[30:33], v[14:17], v[120:123]
    buffer_load_dwordx4 v[18:21], v83, s[52:55], s36 offen offset:0
    buffer_load_dwordx4 v[22:25], v83, s[52:55], s36 offen offset:1024
    buffer_load_dwordx4 v[26:29], v83, s[52:55], s36 offen offset:2048
    buffer_load_dwordx4 v[30:33], v83, s[52:55], s36 offen offset:3072
    v_mul_f32 v114, s80, v114
    v_mul_f32 v115, s80, v115
    v_mul_f32 v116, s80, v116
    v_mul_f32 v117, s80, v117
    v_mul_f32 v120, s80, v120
    v_mul_f32 v121, s80, v121
    v_mul_f32 v122, s80, v122
    v_mul_f32 v123, s80, v123
    s_mov_b32 s65, 0
    s_waitcnt vmcnt(0)
K2_D1:
    s_add_u32 s68, s68, s69
    s_cmp_lt_u32 s68, 2048
    s_cbranch_scc1 K2_NEXT
    s_or_b64 s[76:77], s[72:73], s[74:75]
    s_cbranch_scc1 K2_NEXTCHUNK
    s_and_b32 s71, s60, 7
    v_lshrrev_b32 v107, 5, v1
    v_and_b32 v108, 15, v1
    v_and_b32 v109, 48, v1
    s_cmp_eq_u32 s93, 0
    s_cbranch_scc1 K2_E3
    v_mov_b32 v50, 0
    v_mov_b32 v51, 0
    v_mov_b32 v52, 0
    v_mov_b32 v53, 0
    v_mov_b32 v54, 0
    v_mov_b32 v55, 0
    v_mov_b32 v56, 0
    v_mov_b32 v57, 0
    v_mov_b32 v58, 0
    v_mov_b32 v59, 0
    v_mov_b32 v60, 0
    v_mov_b32 v61, 0
    v_mov_b32 v62, 0
    v_mov_b32 v63, 0
    v_mov_b32 v64, 0
    v_mov_b32 v65, 0
    v_mov_b32 v66, 0
    v_mov_b32 v67, 0
    v_mov_b32 v68, 0
    v_mov_b32 v69, 0
    v_mov_b32 v70, 0
    v_mov_b32 v71, 0
    v_mov_b32 v72, 0
    v_mov_b32 v73, 0
    v_mov_b32 v74, 0
    v_mov_b32 v75, 0
    v_mov_b32 v76, 0
    v_mov_b32 v77, 0
    v_mov_b32 v78, 0
    v_mov_b32 v79, 0
    v_mov_b32 v80, 0
    v_mov_b32 v81, 0
K2_E3:
    s_mul_i32 s70, s61, -48
    s_add_u32 s70, s70, 336
    v_lshl_add_u32 v124, v107, 4, v113
    v_add_u32 v124, s70, v124
    s_mul_i32 s70, s61, 112
    v_mul_u32_u24 v125, 304, v107
    v_add3_u32 v125, v125, v113, s70
    v_cvt_pk_bf16_f32 v66, v66, v50
    ds_write_b32 v124, v66 offset:0
    v_cvt_pk_bf16_f32 v67, v67, v51
    ds_write_b32 v125, v67 offset:1088
    v_cvt_pk_bf16_f32 v68, v68, v52
    ds_write_b32 v125, v68 offset:1232
    v_cvt_pk_bf16_f32 v69, v69, v53
    ds_write_b32 v125, v69 offset:1376
    v_cvt_pk_bf16_f32 v70, v70, v54
    ds_write_b32 v124, v70 offset:288
    v_cvt_pk_bf16_f32 v71, v71, v55
    ds_write_b32 v125, v71 offset:1952
    v_cvt_pk_bf16_f32 v72, v72, v56
    ds_write_b32 v125, v72 offset:2096
    v_cvt_pk_bf16_f32 v73, v73, v57
    ds_write_b32 v125, v73 offset:2240
    s_mov_b64 exec, s[86:87]
    v_cvt_pk_bf16_f32 v74, v74, v58
    ds_write_b32 v124, v74 offset:576
    v_cvt_pk_bf16_f32 v75, v75, v59
    ds_write_b32 v125, v75 offset:2816
    v_cvt_pk_bf16_f32 v76, v76, v60
    ds_write_b32 v125, v76 offset:2960
    v_cvt_pk_bf16_f32 v77, v77, v61
    ds_write_b32 v125, v77 offset:3104
    s_mov_b64 exec, -1
    v_mul_u32_u24 v126, 272, v108
    s_lshl_b32 s70, s71, 5
    v_lshrrev_b32 v111, 1, v109
    v_add_u32 v111, s70, v111
    v_lshl_add_u32 v112, v108, 8, v111
    v_add_u32 v111, v111, v126
    v_add_u32 v111, 82944, v111
    s_mul_i32 s70, s2, 10240
    s_cmp_ge_u32 s60, 8
    s_cbranch_scc1 K2_E2
    ds_read_b64 v[62:63], v111
    ds_read_b64 v[64:65], v111 offset:4352
    v_mul_u32_u24 v126, 205, v108
    v_lshrrev_b32 v126, 10, v126
    v_mul_u32_u24 v126, 7424, v126
    v_mul_u32_u24 v127, 144, v108
    v_add3_u32 v110, v126, v127, v109
    v_add_u32 v110, 94160, v110
    v_add_u32 v108, 16, v108
    v_mul_u32_u24 v126, 205, v108
    v_lshrrev_b32 v126, 10, v126
    v_mul_u32_u24 v126, 7424, v126
    v_mul_u32_u24 v127, 144, v108
    v_add3_u32 v113, v126, v127, v109
    v_add_u32 v113, 94160, v113
    s_waitcnt lgkmcnt(0)
    s_barrier
    ds_read_b128 v[34:37], v110 offset:0
    ds_read_b128 v[38:41], v110 offset:64
    ds_read_b128 v[42:45], v110 offset:4096
    ds_read_b128 v[46:49], v110 offset:4160
    ds_read_b128 v[82:85], v113 offset:0
    ds_read_b128 v[86:89], v113 offset:64
    ds_read_b128 v[90:93], v113 offset:4096
    ds_read_b128 v[94:97], v113 offset:4160
    s_waitcnt lgkmcnt(7)
    v_mfma_f32_16x16x32_bf16 v[120:123], v[18:21], v[34:37], v[120:123]
    s_waitcnt lgkmcnt(6)
    v_mfma_f32_16x16x32_bf16 v[120:123], v[22:25], v[38:41], v[120:123]
    s_waitcnt lgkmcnt(5)
    v_mfma_f32_16x16x32_bf16 v[120:123], v[26:29], v[42:45], v[120:123]
    s_waitcnt lgkmcnt(4)
    v_mfma_f32_16x16x32_bf16 v[120:123], v[30:33], v[46:49], v[120:123]
    s_waitcnt lgkmcnt(3)
    v_mfma_f32_16x16x32_bf16 v[114:117], v[18:21], v[82:85], v[114:117]
    s_waitcnt lgkmcnt(2)
    v_mfma_f32_16x16x32_bf16 v[114:117], v[22:25], v[86:89], v[114:117]
    s_waitcnt lgkmcnt(1)
    v_mfma_f32_16x16x32_bf16 v[114:117], v[26:29], v[90:93], v[114:117]
    s_waitcnt lgkmcnt(0)
    v_mfma_f32_16x16x32_bf16 v[114:117], v[30:33], v[94:97], v[114:117]
    v_exp_f32 v50, v120
    v_exp_f32 v51, v121
    v_exp_f32 v52, v122
    v_exp_f32 v53, v123
    v_add_f32 v50, 1.0, v50
    v_add_f32 v51, 1.0, v51
    v_add_f32 v52, 1.0, v52
    v_add_f32 v53, 1.0, v53
    v_rcp_f32 v50, v50
    v_rcp_f32 v51, v51
    v_rcp_f32 v52, v52
    v_rcp_f32 v53, v53
    v_lshlrev_b32 v54, 16, v62
    v_and_b32 v55, s82, v62
    v_lshlrev_b32 v56, 16, v63
    v_and_b32 v57, s82, v63
    v_mul_f32 v50, v50, v120
    v_mul_f32 v51, v51, v121
    v_mul_f32 v52, v52, v122
    v_mul_f32 v53, v53, v123
    v_fma_f32 v50, v50, s81, v54
    v_fma_f32 v51, v51, s81, v55
    v_fma_f32 v52, v52, s81, v56
    v_fma_f32 v53, v53, s81, v57
    v_cvt_pk_bf16_f32 v58, v50, v51
    v_cvt_pk_bf16_f32 v59, v52, v53
    buffer_store_dwordx2 v[58:59], v112, s[48:51], s70 offen
    s_add_u32 s70, s70, 4096
    v_exp_f32 v50, v114
    v_exp_f32 v51, v115
    v_exp_f32 v52, v116
    v_exp_f32 v53, v117
    v_add_f32 v50, 1.0, v50
    v_add_f32 v51, 1.0, v51
    v_add_f32 v52, 1.0, v52
    v_add_f32 v53, 1.0, v53
    v_rcp_f32 v50, v50
    v_rcp_f32 v51, v51
    v_rcp_f32 v52, v52
    v_rcp_f32 v53, v53
    v_lshlrev_b32 v54, 16, v64
    v_and_b32 v55, s82, v64
    v_lshlrev_b32 v56, 16, v65
    v_and_b32 v57, s82, v65
    v_mul_f32 v50, v50, v114
    v_mul_f32 v51, v51, v115
    v_mul_f32 v52, v52, v116
    v_mul_f32 v53, v53, v117
    v_fma_f32 v50, v50, s81, v54
    v_fma_f32 v51, v51, s81, v55
    v_fma_f32 v52, v52, s81, v56
    v_fma_f32 v53, v53, s81, v57
    v_cvt_pk_bf16_f32 v60, v50, v51
    v_cvt_pk_bf16_f32 v61, v52, v53
    buffer_store_dwordx2 v[60:61], v112, s[48:51], s70 offen
    s_endpgm
K2_E2:
    ds_read_b64 v[62:63], v111 offset:8704
    v_add_u32 v126, 82688, v109
    ds_read_b128 v[2:5], v126 offset:0
    ds_read_b128 v[6:9], v126 offset:64
    ds_read_b128 v[10:13], v126 offset:128
    ds_read_b128 v[14:17], v126 offset:192
    s_lshl_b32 s63, s71, 4
    v_add_u32 v98, s63, v108
    v_min_u32 v98, 119, v98
    v_mul_u32_u24 v126, 137, v98
    v_lshrrev_b32 v126, 11, v126
    v_mul_u32_u24 v126, 6144, v126
    v_mul_u32_u24 v127, 144, v98
    v_add3_u32 v113, v126, v127, v109
    v_add_u32 v113, 94912, v113
    v_mul_u32_u24 v126, 137, v98
    v_lshrrev_b32 v126, 11, v126
    v_mul_u32_u24 v126, 624, v126
    v_mul_u32_u24 v127, 171, v98
    v_lshrrev_b32 v127, 9, v127
    v_mul_u32_u24 v127, 116, v127
    v_lshl_add_u32 v127, v98, 2, v127
    v_sub_u32 v127, v127, v126
    v_add_u32 v127, 82048, v127
    ds_read_b32 v98, v127
    v_add_u32 v108, 32, v108
    v_min_u32 v108, 39, v108
    v_mul_u32_u24 v126, 205, v108
    v_lshrrev_b32 v126, 10, v126
    v_mul_u32_u24 v126, 7424, v126
    v_mul_u32_u24 v127, 144, v108
    v_add3_u32 v110, v126, v127, v109
    v_add_u32 v110, 94160, v110
    s_mul_i32 s85, s2, 240
    s_lshl_b32 s69, s71, 5
    s_add_u32 s85, s85, s69
    s_add_u32 s85, s85, 2560000
    v_lshlrev_b32 v99, 1, v1
    s_add_u32 s70, s70, 8192
    s_waitcnt lgkmcnt(0)
    s_barrier
    ds_read_b128 v[34:37], v110 offset:0
    ds_read_b128 v[38:41], v110 offset:64
    ds_read_b128 v[42:45], v110 offset:4096
    ds_read_b128 v[46:49], v110 offset:4160
    ds_read_b128 v[82:85], v113 offset:0
    ds_read_b128 v[86:89], v113 offset:64
    ds_read_b128 v[90:93], v113 offset:4096
    ds_read_b128 v[94:97], v113 offset:4160
    s_waitcnt lgkmcnt(7)
    v_mfma_f32_16x16x32_bf16 v[120:123], v[18:21], v[34:37], v[120:123]
    s_waitcnt lgkmcnt(6)
    v_mfma_f32_16x16x32_bf16 v[120:123], v[22:25], v[38:41], v[120:123]
    s_waitcnt lgkmcnt(5)
    v_mfma_f32_16x16x32_bf16 v[120:123], v[26:29], v[42:45], v[120:123]
    s_waitcnt lgkmcnt(4)
    v_mfma_f32_16x16x32_bf16 v[120:123], v[30:33], v[46:49], v[120:123]
    s_waitcnt lgkmcnt(3)
    v_mfma_f32_16x16x32_bf16 v[114:117], v[2:5], v[82:85], 0
    s_waitcnt lgkmcnt(2)
    v_mfma_f32_16x16x32_bf16 v[114:117], v[6:9], v[86:89], v[114:117]
    s_waitcnt lgkmcnt(1)
    v_mfma_f32_16x16x32_bf16 v[114:117], v[10:13], v[90:93], v[114:117]
    s_waitcnt lgkmcnt(0)
    v_mfma_f32_16x16x32_bf16 v[114:117], v[14:17], v[94:97], v[114:117]
    v_exp_f32 v50, v120
    v_exp_f32 v51, v121
    v_exp_f32 v52, v122
    v_exp_f32 v53, v123
    v_add_f32 v50, 1.0, v50
    v_add_f32 v51, 1.0, v51
    v_add_f32 v52, 1.0, v52
    v_add_f32 v53, 1.0, v53
    v_rcp_f32 v50, v50
    v_rcp_f32 v51, v51
    v_rcp_f32 v52, v52
    v_rcp_f32 v53, v53
    v_lshlrev_b32 v54, 16, v62
    v_and_b32 v55, s82, v62
    v_lshlrev_b32 v56, 16, v63
    v_and_b32 v57, s82, v63
    v_mul_f32 v50, v50, v120
    v_mul_f32 v51, v51, v121
    v_mul_f32 v52, v52, v122
    v_mul_f32 v53, v53, v123
    v_fma_f32 v50, v50, s81, v54
    v_fma_f32 v51, v51, s81, v55
    v_fma_f32 v52, v52, s81, v56
    v_fma_f32 v53, v53, s81, v57
    v_cvt_pk_bf16_f32 v58, v50, v51
    v_cvt_pk_bf16_f32 v59, v52, v53
    s_mov_b64 exec, s[88:89]
    buffer_store_dwordx2 v[58:59], v112, s[48:51], s70 offen
    s_mov_b64 exec, -1
    v_fma_f32 v114, v114, s81, v98
    v_cvt_pk_bf16_f32 v114, v114, v114
    v_add_u32 v127, s63, v1
    v_cmp_gt_u32 vcc, 120, v127
    v_cmp_gt_u32 s[76:77], 16, v1
    s_and_b64 exec, vcc, s[76:77]
    s_cbranch_execz K2_ENDP
    buffer_store_short v114, v99, s[48:51], s85 offen
    s_endpgm
K2_R2:
    v_and_b32 v45, 0x1c, v3
    s_mov_b64 exec, s[76:77]
    ds_add_rtn_u32 v42, v44, v88 offset:0
    s_mov_b64 exec, s[78:79]
    ds_add_rtn_u32 v43, v45, v88 offset:0
    buffer_load_dwordx2 v[102:103], v7, s[52:55], s94 offen offset:128
    v_and_b32 v41, 0x3fff00, v3
    v_lshrrev_b32 v15, 4, v41
    buffer_load_dwordx3 v[98:100], v15, s[52:55], s95 offen
    s_mov_b64 exec, s[76:77]
    v_and_b32 v40, 0x3fff00, v2
    v_lshrrev_b32 v85, 4, v40
    buffer_load_dwordx3 v[106:108], v85, s[52:55], s95 offen
    s_mov_b64 exec, -1
    v_bfe_u32 v46, v2, 5, 3
    v_lshl_add_u32 v86, v44, 7, s42
    v_lshlrev_b32 v48, 3, v46
    v_and_b32 v85, 0xfc, v2
    v_lshl_add_u32 v85, v85, 2, s44
    v_bfe_u32 v47, v3, 5, 3
    v_lshl_add_u32 v87, v45, 7, s42
    v_lshlrev_b32 v49, 3, v47
    v_and_b32 v15, 0xfc, v3
    v_lshl_add_u32 v15, v15, 2, s44
    s_waitcnt lgkmcnt(0)
    v_cmp_gt_u32 vcc, v86, v42
    v_lshlrev_b32 v44, 2, v42
    v_lshl_add_u32 v46, v46, 1, v44
    s_and_b64 s[76:77], vcc, s[76:77]
    s_mov_b64 exec, s[76:77]
    ds_write_b32 v42, v40 offset:41088
    ds_write_b16 v46, v89 offset:45184
    v_mad_u32_u24 v48, v42, 10, v48
    s_mov_b64 exec, -1
    v_cmp_gt_u32 vcc, v87, v43
    v_lshlrev_b32 v45, 2, v43
    v_lshl_add_u32 v47, v47, 1, v45
    s_and_b64 s[78:79], vcc, s[78:79]
    s_mov_b64 exec, s[78:79]
    ds_write_b32 v43, v41 offset:41088
    ds_write_b16 v47, v89 offset:45184
    v_mad_u32_u24 v49, v43, 10, v49
    s_mov_b64 exec, -1
    s_branch K2_R3
K2_RESTART:
    s_mov_b32 s69, 128
    s_mov_b32 s68, 0
    s_branch K2_NEXT
K2_NEXTCHUNK:
    s_mov_b32 s68, 0
    s_mov_b32 s69, 2048
    s_cmp_eq_u64 s[72:73], 0
    s_cbranch_scc1 K2_N1
    s_ff1_i32_b64 s83, s[72:73]
    s_bitset0_b64 s[72:73], s83
    s_mov_b32 s84, 0
    s_branch K2_NEXT
K2_N1:
    s_ff1_i32_b64 s83, s[74:75]
    s_bitset0_b64 s[74:75], s83
    s_mov_b32 s84, 2048
K2_NEXT:
    s_waitcnt vmcnt(0) lgkmcnt(0)
    s_barrier
    v_lshlrev_b32 v82, 3, v0
    v_lshlrev_b32 v4, 4, v0
    v_lshrrev_b32 v126, 4, v0
    v_lshl_add_u32 v83, v126, 4, v0
    v_lshl_add_u32 v7, v126, 7, v82
    v_add_u32 v7, 0x2000, v7
    s_cmp_lg_u32 s83, -1
    s_cbranch_scc1 K2_N2
    buffer_load_dwordx2 v[2:3], v82, s[52:55], s94 offen
    s_waitcnt vmcnt(0)
    s_branch K2_N3
K2_N2:
    s_lshl_b32 s70, s83, 14
    s_lshl_b32 s71, s84, 2
    s_add_u32 s70, s70, s71
    s_lshl_b32 s94, s70, 1
    s_add_u32 s94, s94, 17817600
    s_add_u32 s71, s70, 23068672
    s_add_u32 s70, s70, 22020096
    buffer_load_dwordx2 v[2:3], v82, s[52:55], s70 offen
    buffer_load_dwordx2 v[84:85], v82, s[52:55], s71 offen
    v_lshlrev_b32 v86, 2, v1
    s_mov_b32 s70, 17039360
    buffer_load_dword v86, v86, s[52:55], s70 offen
    s_waitcnt vmcnt(0)
    v_readlane_b32 s70, v86, s83
    s_sub_u32 s70, s70, s84
    v_add_u32 v86, 0, v83
    v_cmp_gt_u32 vcc, s70, v86
    s_nop 1
    v_cndmask_b32 v2, -1, v2, vcc
    v_cmp_eq_u32 vcc, s2, v84
    s_nop 1
    v_cndmask_b32 v2, -1, v2, vcc
    v_add_u32 v86, 16, v83
    v_cmp_gt_u32 vcc, s70, v86
    s_nop 1
    v_cndmask_b32 v3, -1, v3, vcc
    v_cmp_eq_u32 vcc, s2, v85
    s_nop 1
    v_cndmask_b32 v3, -1, v3, vcc
K2_N3:
    v_add_u32 v86, 0, v83
    v_subrev_u32 v86, s68, v86
    v_cmp_gt_u32 vcc, s69, v86
    s_nop 1
    v_cndmask_b32 v2, -1, v2, vcc
    v_add_u32 v86, 16, v83
    v_subrev_u32 v86, s68, v86
    v_cmp_gt_u32 vcc, s69, v86
    s_nop 1
    v_cndmask_b32 v3, -1, v3, vcc
    v_mov_b32 v98, 0
    v_mov_b32 v99, 0
    v_mov_b32 v100, 0
    v_mov_b32 v101, 0
    v_add_u32 v127, 0x10000, v4
    ds_write_b128 v4, v[98:101] offset:128
    ds_write_b128 v4, v[98:101] offset:16512
    ds_write_b128 v4, v[98:101] offset:32896
    ds_write_b128 v4, v[98:101] offset:49280
    ds_write_b128 v127, v[98:101] offset:128
    v_lshrrev_b32 v8, 2, v118
    v_lshlrev_b32 v9, 5, v118
    ds_write_b32 v8, v9 offset:0
    ds_write_b32 v8, v98 offset:64
    buffer_load_dwordx2 v[12:13], v7, s[52:55], s94 offen
    s_waitcnt vmcnt(0) lgkmcnt(0)
    s_barrier
    s_branch K2_REC
    s_endpgm
K2_ENDP:
K2_END:
    s_endpgm
.section .rodata,"a"
.p2align 6
.amdhsa_kernel egnn_k1_kernel
  .amdhsa_next_free_vgpr 128
  .amdhsa_next_free_sgpr 64
  .amdhsa_accum_offset 128
  .amdhsa_group_segment_fixed_size 0
  .amdhsa_kernarg_size 88
  .amdhsa_user_sgpr_count 2
  .amdhsa_user_sgpr_kernarg_segment_ptr 1
  .amdhsa_system_sgpr_workgroup_id_x 1
.end_amdhsa_kernel
.p2align 6
.amdhsa_kernel egnn_k2_kernel
  .amdhsa_next_free_vgpr 128
  .amdhsa_next_free_sgpr 96
  .amdhsa_accum_offset 128
  .amdhsa_group_segment_fixed_size 0
  .amdhsa_kernarg_size 88
  .amdhsa_user_sgpr_count 2
  .amdhsa_user_sgpr_kernarg_segment_ptr 1
  .amdhsa_system_sgpr_workgroup_id_x 1
.end_amdhsa_kernel
```
